```python
import torch

def _softmax(x, axis=-1):
    return torch.softmax(x, dim=axis)

def _gelu(x):
    return torch.nn.functional.gelu(x, approximate='tanh')

def _silu(x):
    return torch.nn.functional.silu(x)

def _sigmoid(x):
    return torch.sigmoid(x)

def _layernorm(x, axis=-1, eps=1e-05):
    m = x.mean(dim=axis, keepdim=True)
    v = x.var(dim=axis, keepdim=True, unbiased=False)
    return (x - m) / torch.sqrt(v + eps)

def _scatter_add(tgt, idx, src, axis=0):
    return tgt.clone().index_add_(axis, idx, src)

def _segment_sum(src, seg, n):
    out = torch.zeros((n,) + src.shape[1:], dtype=src.dtype)
    return out.index_add_(0, seg, src)

def _pad(x, pw):
    flat = tuple((v for pair in reversed(pw) for v in pair))
    return torch.nn.functional.pad(x, flat)
kernel_name = 'standalone__kv_cache_quant_pre_rope_vs_post_rope__prompt'

def setup_inputs():

    _w = lambda a: (lambda t: t.to(torch.bfloat16) if t.is_floating_point() else t)(torch.as_tensor(a))
    B, Sq, Skv = (1, 2048, 2048)
    H, Dh0 = (4, 128)
    G = 64 if 64 > 0 else Dh0
    G = max(2, G // 2 * 2)
    Dh = max(G, Dh0 // G * G)
    Skv = max(Skv, Sq)
    ng = Dh // G
    bits = 8 if 8 > 1 else 4
    bits = max(2, min(8, bits))
    qmax = (1 << bits) - 1
    half = Dh // 2
    inv = 1.0 / 10000.0 ** (torch.arange(half) / max(1, half))
    ang_k = torch.arange(Skv)[:, None] * inv[None, :]
    ang_q = torch.arange(Skv - Sq, Skv)[:, None] * inv[None, :]
    kc = torch.cat([torch.cos(ang_k), torch.cos(ang_k)], dim=-1)
    ks = torch.cat([torch.sin(ang_k), torch.sin(ang_k)], dim=-1)
    qc = torch.cat([torch.cos(ang_q), torch.cos(ang_q)], dim=-1)
    qs = torch.cat([torch.sin(ang_q), torch.sin(ang_q)], dim=-1)
    qk_i = torch.randint(0, qmax + 1, (B, H, Skv, Dh)).to(torch.int32)
    qv_i = torch.randint(0, qmax + 1, (B, H, Skv, Dh)).to(torch.int32)
    ksc = torch.abs((lambda *s: torch.randn(*s, dtype=torch.bfloat16) * 0.05)(B, H, Skv, ng)) * 0.1 + 0.01
    kzp = torch.full((B, H, Skv, ng), qmax / 2.0)
    vsc = torch.abs((lambda *s: torch.randn(*s, dtype=torch.bfloat16) * 0.05)(B, H, Skv, ng)) * 0.1 + 0.01
    vzp = torch.full((B, H, Skv, ng), qmax / 2.0)
    return {'q': _w((lambda *s: torch.randn(*s, dtype=torch.bfloat16) * 0.8)(B, H, Sq, Dh) * 0.5), 'qk': _w(qk_i), 'k_scales': _w(ksc), 'k_zeros': _w(kzp), 'qv': _w(qv_i), 'v_scales': _w(vsc), 'v_zeros': _w(vzp), 'q_cos': _w(qc), 'q_sin': _w(qs), 'k_cos': _w(kc), 'k_sin': _w(ks)}

def reference(q, qk, k_scales, k_zeros, qv, v_scales, v_zeros, q_cos, q_sin, k_cos, k_sin):
    B, H, Sq, Dh = q.shape
    ng = k_scales.shape[-1]
    G = Dh // ng
    half = Dh // 2
    ks = (lambda x, n, axis: torch.repeat_interleave(x, n, dim=axis))(k_scales, G, axis=-1)
    kz = (lambda x, n, axis: torch.repeat_interleave(x, n, dim=axis))(k_zeros, G, axis=-1)
    k = ((lambda x, dt: x.to(dt))(qk, q.dtype) - kz) * ks
    vs = (lambda x, n, axis: torch.repeat_interleave(x, n, dim=axis))(v_scales, G, axis=-1)
    vz = (lambda x, n, axis: torch.repeat_interleave(x, n, dim=axis))(v_zeros, G, axis=-1)
    v = ((lambda x, dt: x.to(dt))(qv, q.dtype) - vz) * vs
    k1 = k[..., :half].clone()
    k2 = k[..., half:].clone()
    krh = torch.concatenate([-k2, k1], axis=-1)
    kr = k * k_cos[None, None, :, :] + krh * k_sin[None, None, :, :]
    q1 = q[..., :half].clone()
    q2 = q[..., half:].clone()
    qrh = torch.concatenate([-q2, q1], axis=-1)
    qr = q * q_cos[None, None, :, :] + qrh * q_sin[None, None, :, :]
    logits = torch.einsum('bhqd,bhkd->bhqk', qr, kr) * float(Dh) ** (-0.5)
    attn = _softmax(logits, axis=-1)
    out = torch.einsum('bhqk,bhkd->bhqd', attn, v)
    return out
```

```asm
; @launch grid=(256,1,1) block=(256,1,1) lds=98304
.amdgcn_target "amdgcn-amd-amdhsa--gfx950"
.text
.p2align 12
.globl standalone__kv_cache_quant_pre_rope_vs_post_rope__prompt_kernel
.p2align 8
.type standalone__kv_cache_quant_pre_rope_vs_post_rope__prompt_kernel,@function
standalone__kv_cache_quant_pre_rope_vs_post_rope__prompt_kernel:
    s_cmpk_ge_u32 s2, 0x100
    s_cbranch_scc1 L_end
    s_load_dwordx16 s[4:19], s[0:1], 0
    s_load_dwordx8 s[20:27], s[0:1], 64
    s_load_dwordx4 s[28:31], s[0:1], 96
    s_getpc_b64 s[40:41]
L_pc:
    s_lshr_b32 s42, s2, 3
    s_lshl_b32 s42, s42, 10
    v_lshl_add_u32 v209, v0, 2, s42
    global_load_dword v255, v209, s[40:41]
    s_lshl_b32 s49, s2, 14
    v_lshrrev_b32 v213, 3, v0
    v_lshl_add_u32 v214, v0, 5, s49
    v_lshl_add_u32 v214, v213, 8, v214
    s_waitcnt lgkmcnt(0)
    global_load_dwordx4 v[16:19], v214, s[6:7] nt
    global_load_dwordx4 v[24:27], v214, s[6:7] offset:256 nt
    global_load_dwordx4 v[20:23], v214, s[6:7] offset:16 nt
    global_load_dwordx4 v[28:31], v214, s[6:7] offset:272 nt
    s_lshl_b32 s40, s2, 5
    v_add_u32 v213, s40, v213
    v_lshlrev_b32 v215, 2, v213
    v_lshrrev_b32 v216, 1, v214
    v_and_b32 v216, 0x7ffff, v216
    v_lshrrev_b32 v209, 6, v0
    v_and_b32 v0, 63, v0
    v_readfirstlane_b32 s35, v209
    global_load_dword v48, v215, s[8:9]
    global_load_dword v49, v215, s[10:11]
    global_load_dwordx4 v[32:35], v216, s[22:23] nt
    global_load_dwordx4 v[40:43], v216, s[24:25] nt
    global_load_dwordx4 v[36:39], v216, s[22:23] offset:128 nt
    global_load_dwordx4 v[44:47], v216, s[24:25] offset:128 nt
    s_add_u32 s46, s30, 4227072
    s_addc_u32 s47, s31, 0
    s_load_dword s37, s[46:47], 0
    v_lshrrev_b32 v211, 4, v0
    v_and_b32 v212, 15, v0
    s_cmp_ge_u32 s35, 2
    s_cbranch_scc1 L_qrole
    v_lshl_add_u32 v237, v211, 2, s40
    v_lshlrev_b32 v238, 9, v237
    v_lshl_add_u32 v238, v212, 4, v238
    s_lshl_b32 s44, s35, 8
    v_add_u32 v238, s44, v238
    v_add_u32 v239, 0x2000, v238
    v_and_b32 v236, 31, v0
    s_lshl_b32 s44, s2, 7
    v_lshl_add_u32 v237, v236, 2, s44
    global_load_dword v112, v237, s[14:15]
    global_load_dword v113, v237, s[16:17]
    global_load_dwordx4 v[80:83], v238, s[12:13] offset:0 nt
    global_load_dwordx4 v[84:87], v238, s[12:13] offset:512 nt
    global_load_dwordx4 v[88:91], v238, s[12:13] offset:1024 nt
    global_load_dwordx4 v[92:95], v238, s[12:13] offset:1536 nt
    global_load_dwordx4 v[96:99], v239, s[12:13] offset:0 nt
    global_load_dwordx4 v[100:103], v239, s[12:13] offset:512 nt
    global_load_dwordx4 v[104:107], v239, s[12:13] offset:1024 nt
    global_load_dwordx4 v[108:111], v239, s[12:13] offset:1536 nt
    s_bfe_u32 s32, s2, 0x20001
    s_and_b32 s33, s2, 1
    s_lshl_b32 s33, s33, 4
    s_lshr_b32 s40, s2, 4
    s_add_u32 s33, s33, s40
    s_bfe_u32 s34, s2, 0x10003
    s_mov_b32 s38, 0x05040100
    s_mov_b32 s39, 0x07060302
    v_lshrrev_b32 v209, 3, v0
    v_and_b32 v210, 7, v0
    s_lshr_b32 s42, s35, 1
    s_and_b32 s43, s35, 1
    s_mul_i32 s44, s35, 2304
    s_add_u32 s44, s44, 17408
    s_movk_i32 s45, 144
    v_lshl_add_u32 v213, v209, 4, s44
    v_mad_u32_u24 v213, v210, s45, v213
    v_lshl_add_u32 v214, v210, 4, s44
    v_mad_u32_u24 v214, v209, s45, v214
    s_lshr_b32 s40, s2, 6
    s_lshl_b32 s40, s40, 12
    s_add_u32 s40, s40, 0x1000
    s_add_u32 s49, s49, s40
    s_mov_b32 s40, s49
    s_lshl_b32 s44, s42, 12
    s_lshl_b32 s45, s43, 7
    s_add_u32 s45, s45, s44
    s_add_u32 s45, s45, s40
    v_lshl_add_u32 v215, v210, 4, s45
    v_lshl_add_u32 v215, v209, 8, v215
    s_getreg_b32 s53, hwreg(HW_REG_XCC_ID, 0, 4)
    s_mov_b32 s48, 0x3e0293ee
    s_lshl_b32 s46, s34, 1
    s_xor_b32 s46, s46, 2
    s_xor_b32 s46, s46, s35
    s_lshl_b32 s46, s46, 4
    s_lshl_b32 s47, s33, 6
    s_add_u32 s46, s46, s47
    v_add_u32 v224, s46, v209
    v_lshlrev_b32 v224, 8, v224
    v_lshl_add_u32 v224, v210, 4, v224
    s_lshl_b32 s47, s32, 19
    v_add_u32 v219, s47, v224
    s_lshl_b32 s46, s35, 12
    v_xor_b32 v217, v209, v210
    v_lshl_add_u32 v217, v217, 4, s46
    v_lshl_add_u32 v217, v210, 8, v217
    s_lshl_b32 s46, s34, 11
    v_add_u32 v224, s46, v224
    v_add_u32 v219, s46, v219
    v_xor_b32 v225, 0x800, v224
    v_xor_b32 v227, 0x800, v219
    s_lshl_b32 s46, s34, 7
    s_xor_b32 s47, s46, 0x80
    v_add_u32 v234, s47, v217
    v_add_u32 v217, s46, v217
    s_lshl_b32 s45, s35, 12
    s_add_u32 s45, s45, s49
    s_add_u32 s45, s45, 0x2000
    v_lshl_add_u32 v216, v0, 4, s45
    s_mul_i32 s50, s35, 0x02020000
    s_add_u32 s50, s50, 0x01000c0c
    s_lshr_b32 s42, s35, 1
    s_and_b32 s43, s35, 1
    s_lshl_b32 s44, s42, 12
    v_xor_b32 v218, v212, v211
    v_lshl_add_u32 v218, v218, 4, s44
    v_lshl_add_u32 v218, v211, 8, v218
    v_xor_b32 v220, 0x1000, v218
    v_xor_b32 v232, 64, v218
    v_xor_b32 v233, 64, v220
    s_lshl_b32 s44, s32, 1
    s_add_u32 s44, s44, s34
    s_lshl_b32 s44, s44, 2
    s_add_u32 s44, s44, s35
    s_lshl_b32 s45, s44, 3
    v_add_u32 v221, s45, v0
    s_xor_b32 s45, s2, 8
    v_mov_b32 v222, s45
    v_cmp_gt_u32 vcc, 8, v0
    s_lshl_b32 s44, s44, 17
    s_lshl_b32 s54, s32, 12
    s_add_u32 s54, s54, 0x1000
    s_add_u32 s54, s54, s44
    s_add_u32 s54, s30, s54
    s_addc_u32 s55, s31, 0
    v_cndmask_b32 v221, v222, v221, vcc
    v_lshlrev_b32 v221, 11, v221
    v_add_u32 v1, 4259840, v221
    s_lshr_b32 s44, s44, 3
    s_add_u32 s44, s44, 4259840
    s_add_u32 s0, s30, s44
    s_addc_u32 s1, s31, 0
    v_lshlrev_b32 v244, 4, v0
    v_add_u32 v245, 0x1000, v244
    s_lshl_b32 s45, s43, 12
    s_add_u32 s45, s45, 0x2000
    v_add_u32 v246, s45, v244
    v_xor_b32 v247, 0x1000, v246
    v_mov_b32 v222, 26624
    v_mov_b32 v223, 0
    ds_write2_b32 v222, v223, v223 offset0:0 offset1:1
    s_add_u32 s56, s54, 0
    s_addc_u32 s57, s55, 0
    s_add_u32 s58, s54, 16384
    s_addc_u32 s59, s55, 0
    s_add_u32 s60, s54, 32768
    s_addc_u32 s61, s55, 0
    s_add_u32 s62, s54, 49152
    s_addc_u32 s63, s55, 0
    s_add_u32 s64, s54, 65536
    s_addc_u32 s65, s55, 0
    s_add_u32 s66, s54, 81920
    s_addc_u32 s67, s55, 0
    s_add_u32 s68, s54, 98304
    s_addc_u32 s69, s55, 0
    s_add_u32 s70, s54, 114688
    s_addc_u32 s71, s55, 0
    s_mul_i32 s40, s35, 8192
    s_add_u32 s40, s40, 32768
    v_lshl_add_u32 v4, v0, 4, s40
    s_xor_b32 s40, s35, 1
    s_mul_i32 s40, s40, 8192
    s_add_u32 s40, s40, 32768
    v_lshl_add_u32 v5, v0, 4, s40
    s_xor_b32 s40, s35, 2
    s_mul_i32 s40, s40, 8192
    s_add_u32 s40, s40, 32768
    v_lshl_add_u32 v6, v0, 4, s40
    s_xor_b32 s40, s35, 3
    s_mul_i32 s40, s40, 8192
    s_add_u32 s40, s40, 32776
    v_lshl_add_u32 v7, v0, 4, s40
    v_and_b32 v221, 8, v0
    v_xor_b32 v5, v5, v221
    v_xor_b32 v7, v7, v221
    s_lshl_b32 s40, s32, 5
    s_add_u32 s40, s40, s33
    s_lshl_b32 s40, s40, 1
    s_add_u32 s40, s40, s34
    s_lshl_b32 s41, s40, 2
    s_add_u32 s41, s41, s35
    s_lshl_b32 s41, s41, 9
    s_add_u32 s41, s41, 5242880
    v_lshl_add_u32 v11, v0, 3, s41
    s_lshl_b32 s40, s40, 13
    s_lshr_b32 s41, s35, 1
    s_lshl_b32 s41, s41, 12
    s_add_u32 s40, s40, s41
    s_and_b32 s41, s35, 1
    s_lshl_b32 s41, s41, 7
    s_add_u32 s40, s40, s41
    v_lshl_add_u32 v12, v209, 8, s40
    v_lshl_add_u32 v12, v210, 4, v12
    v_xor_b32 v2, 0x2000, v12
    v_min_u32 v3, 15, v0
    v_lshl_add_u32 v3, v3, 8, s40
    s_add_u32 s6, s26, s40
    s_addc_u32 s7, s27, 0
    s_xor_b32 s40, s2, 8
    s_lshl_b32 s40, s40, 11
    s_add_u32 s40, s40, 4259840
    s_add_u32 s10, s30, s40
    s_addc_u32 s11, s31, 0
    s_lshl_b32 s40, s35, 6
    s_cmp_eq_u32 s2, 0
    s_cselect_b32 s40, s40, s2
    s_cselect_b32 s41, 63, 0
    v_and_b32 v8, s41, v0
    v_add_u32 v8, s40, v8
    v_lshlrev_b32 v8, 11, v8
    v_add_u32 v8, 4259840, v8
    v_lshrrev_b32 v221, 2, v212
    v_cmp_eq_u32 vcc, v221, v211
    v_and_b32 v221, 1, v0
    v_lshlrev_b32 v221, 4, v221
    v_mov_b32 v222, 0x3f80
    v_lshlrev_b32 v221, v221, v222
    v_cndmask_b32 v221, 0, v221, vcc
    v_and_b32 v222, 2, v0
    v_cmp_eq_u32 vcc, 0, v222
    v_accvgpr_write_b32 a66, 0
    v_accvgpr_write_b32 a67, 0
    v_cndmask_b32 v222, 0, v221, vcc
    v_cndmask_b32 v223, v221, v223, vcc
    v_accvgpr_write_b32 a68, 0
    v_accvgpr_write_b32 a69, 0
    v_accvgpr_write_b32 a64, v222
    v_accvgpr_write_b32 a65, v223
    v_accvgpr_write_b32 a70, v222
    v_accvgpr_write_b32 a71, v223
    v_accvgpr_write_b32 a72, v222
    v_accvgpr_write_b32 a73, v223
    v_lshlrev_b32 v221, 2, v211
    v_sub_u32 v221, v212, v221
    v_mov_b32 v223, 0x3f803f80
    v_cmp_eq_u32 vcc, 0, v221
    s_nop 1
    v_cndmask_b32 v222, 0, v223, vcc
    v_accvgpr_write_b32 a76, v222
    v_accvgpr_write_b32 a77, v222
    v_accvgpr_write_b32 a78, v222
    v_accvgpr_write_b32 a79, v222
    v_cmp_eq_u32 vcc, 1, v221
    s_nop 1
    v_cndmask_b32 v222, 0, v223, vcc
    v_accvgpr_write_b32 a80, v222
    v_accvgpr_write_b32 a81, v222
    v_accvgpr_write_b32 a82, v222
    v_accvgpr_write_b32 a83, v222
    v_cmp_eq_u32 vcc, 2, v221
    s_nop 1
    v_cndmask_b32 v222, 0, v223, vcc
    v_accvgpr_write_b32 a84, v222
    v_accvgpr_write_b32 a85, v222
    v_accvgpr_write_b32 a86, v222
    v_accvgpr_write_b32 a87, v222
    v_cmp_eq_u32 vcc, 3, v221
    s_nop 1
    v_cndmask_b32 v222, 0, v223, vcc
    v_accvgpr_write_b32 a88, v222
    v_accvgpr_write_b32 a89, v222
    v_accvgpr_write_b32 a90, v222
    v_accvgpr_write_b32 a91, v222
    s_waitcnt vmcnt(16)
    v_cvt_f32_i32 v16, v16
    v_cvt_f32_i32 v17, v17
    v_cvt_f32_i32 v18, v18
    v_cvt_f32_i32 v19, v19
    v_cvt_f32_i32 v20, v20
    v_cvt_f32_i32 v21, v21
    v_cvt_f32_i32 v22, v22
    v_cvt_f32_i32 v23, v23
    v_cvt_f32_i32 v24, v24
    v_cvt_f32_i32 v25, v25
    v_cvt_f32_i32 v26, v26
    v_cvt_f32_i32 v27, v27
    v_cvt_f32_i32 v28, v28
    v_cvt_f32_i32 v29, v29
    v_cvt_f32_i32 v30, v30
    v_cvt_f32_i32 v31, v31
    s_waitcnt vmcnt(14)
    v_lshlrev_b32 v50, 16, v48
    v_and_b32 v52, 0xffff0000, v48
    v_lshlrev_b32 v51, 16, v49
    v_and_b32 v53, 0xffff0000, v49
    v_mul_f32 v50, s48, v50
    v_mul_f32 v52, s48, v52
    v_mul_f32_e64 v51, -v51, v50
    v_mul_f32_e64 v53, -v53, v52
    v_pk_fma_f32 v[16:17], v[16:17], v[50:51], v[50:51] op_sel:[0,0,1] op_sel_hi:[1,0,1]
    v_pk_fma_f32 v[18:19], v[18:19], v[50:51], v[50:51] op_sel:[0,0,1] op_sel_hi:[1,0,1]
    v_pk_fma_f32 v[20:21], v[20:21], v[50:51], v[50:51] op_sel:[0,0,1] op_sel_hi:[1,0,1]
    v_pk_fma_f32 v[22:23], v[22:23], v[50:51], v[50:51] op_sel:[0,0,1] op_sel_hi:[1,0,1]
    v_pk_fma_f32 v[24:25], v[24:25], v[52:53], v[52:53] op_sel:[0,0,1] op_sel_hi:[1,0,1]
    v_pk_fma_f32 v[26:27], v[26:27], v[52:53], v[52:53] op_sel:[0,0,1] op_sel_hi:[1,0,1]
    v_pk_fma_f32 v[28:29], v[28:29], v[52:53], v[52:53] op_sel:[0,0,1] op_sel_hi:[1,0,1]
    v_pk_fma_f32 v[30:31], v[30:31], v[52:53], v[52:53] op_sel:[0,0,1] op_sel_hi:[1,0,1]
    v_cvt_pk_bf16_f32 v16, v16, v24
    v_cvt_pk_bf16_f32 v17, v17, v25
    v_cvt_pk_bf16_f32 v18, v18, v26
    v_cvt_pk_bf16_f32 v19, v19, v27
    v_cvt_pk_bf16_f32 v20, v20, v28
    v_cvt_pk_bf16_f32 v21, v21, v29
    v_cvt_pk_bf16_f32 v22, v22, v30
    v_cvt_pk_bf16_f32 v23, v23, v31
    s_waitcnt lgkmcnt(0)
    s_add_u32 s37, s37, 0x9e3779b1
    s_lshl_b32 s40, s2, 11
    s_add_u32 s40, s40, 4259840
    s_xor_b32 s41, s37, s53
    s_mov_b32 s24, s37
    s_mov_b32 s25, s37
    s_waitcnt vmcnt(12)
    v_perm_b32 v56, v40, v32, s38
    v_perm_b32 v57, v40, v32, s39
    v_perm_b32 v58, v41, v33, s38
    v_perm_b32 v59, v41, v33, s39
    v_perm_b32 v60, v42, v34, s38
    v_perm_b32 v61, v42, v34, s39
    v_perm_b32 v62, v43, v35, s38
    v_perm_b32 v63, v43, v35, s39
    v_dot2_f32_bf16 v56, v16, v56, 0 neg_hi:[0,1,0]
    v_dot2_f32_bf16 v57, v17, v57, 0 neg_hi:[0,1,0]
    v_dot2_f32_bf16 v58, v18, v58, 0 neg_hi:[0,1,0]
    v_dot2_f32_bf16 v59, v19, v59, 0 neg_hi:[0,1,0]
    v_dot2_f32_bf16 v60, v20, v60, 0 neg_hi:[0,1,0]
    v_dot2_f32_bf16 v61, v21, v61, 0 neg_hi:[0,1,0]
    v_dot2_f32_bf16 v62, v22, v62, 0 neg_hi:[0,1,0]
    v_dot2_f32_bf16 v63, v23, v63, 0 neg_hi:[0,1,0]
    v_cvt_pk_bf16_f32 v56, v56, v57
    v_cvt_pk_bf16_f32 v57, v58, v59
    v_cvt_pk_bf16_f32 v58, v60, v61
    v_cvt_pk_bf16_f32 v59, v62, v63
    ds_write_b128 v213, v[56:59] offset:0
    ds_read_b128 v[72:75], v214 offset:0
    s_waitcnt vmcnt(10)
    v_perm_b32 v64, v36, v44, s38
    v_perm_b32 v65, v36, v44, s39
    v_perm_b32 v66, v37, v45, s38
    v_perm_b32 v67, v37, v45, s39
    v_perm_b32 v68, v38, v46, s38
    v_perm_b32 v69, v38, v46, s39
    v_perm_b32 v70, v39, v47, s38
    v_perm_b32 v71, v39, v47, s39
    v_dot2_f32_bf16 v64, v16, v64, 0
    v_dot2_f32_bf16 v65, v17, v65, 0
    v_dot2_f32_bf16 v66, v18, v66, 0
    v_dot2_f32_bf16 v67, v19, v67, 0
    v_dot2_f32_bf16 v68, v20, v68, 0
    v_dot2_f32_bf16 v69, v21, v69, 0
    v_dot2_f32_bf16 v70, v22, v70, 0
    v_dot2_f32_bf16 v71, v23, v71, 0
    s_waitcnt lgkmcnt(0)
    global_store_dwordx4 v215, v[72:75], s[30:31] sc1
    v_cvt_pk_bf16_f32 v64, v64, v65
    v_cvt_pk_bf16_f32 v65, v66, v67
    v_cvt_pk_bf16_f32 v66, v68, v69
    v_cvt_pk_bf16_f32 v67, v70, v71
    ds_write_b128 v213, v[64:67] offset:1152
    ds_read_b128 v[76:79], v214 offset:1152
    v_lshl_add_u32 v226, v0, 4, s40
    v_mov_b32 v228, s41
    v_mov_b32 v229, s37
    v_mov_b32 v230, s41
    v_mov_b32 v231, s41
    s_waitcnt lgkmcnt(0)
    global_store_dwordx4 v215, v[76:79], s[30:31] offset:2048 sc1
    s_lshl_b32 s44, s35, 8
    s_add_u32 s44, s44, 27136
    v_lshl_add_u32 v236, v236, 3, s44
    v_lshl_add_u32 v237, v211, 5, s44
    s_waitcnt vmcnt(10)
    v_perm_b32 v112, v112, v112, s50
    v_perm_b32 v113, v113, v113, s50
    v_mul_f32_e64 v113, -v113, v112
    ds_write_b64 v236, v[112:113]
    ds_read_b128 v[128:131], v237 offset:0
    ds_read_b128 v[132:135], v237 offset:16
    ds_read_b128 v[136:139], v237 offset:128
    ds_read_b128 v[140:143], v237 offset:144
    s_waitcnt vmcnt(8)
    v_cvt_f32_i32 v80, v80
    v_cvt_f32_i32 v81, v81
    v_cvt_f32_i32 v82, v82
    v_cvt_f32_i32 v83, v83
    v_cvt_f32_i32 v84, v84
    v_cvt_f32_i32 v85, v85
    v_cvt_f32_i32 v86, v86
    v_cvt_f32_i32 v87, v87
    s_waitcnt lgkmcnt(0)
    v_pk_fma_f32 v[80:81], v[80:81], v[128:129], v[128:129] op_sel:[0,0,1] op_sel_hi:[1,0,1]
    v_pk_fma_f32 v[82:83], v[82:83], v[128:129], v[128:129] op_sel:[0,0,1] op_sel_hi:[1,0,1]
    v_pk_fma_f32 v[84:85], v[84:85], v[130:131], v[130:131] op_sel:[0,0,1] op_sel_hi:[1,0,1]
    v_pk_fma_f32 v[86:87], v[86:87], v[130:131], v[130:131] op_sel:[0,0,1] op_sel_hi:[1,0,1]
    v_cvt_pk_bf16_f32 v144, v80, v84
    v_cvt_pk_bf16_f32 v148, v81, v85
    v_cvt_pk_bf16_f32 v152, v82, v86
    v_cvt_pk_bf16_f32 v156, v83, v87
    s_waitcnt vmcnt(6)
    v_cvt_f32_i32 v88, v88
    v_cvt_f32_i32 v89, v89
    v_cvt_f32_i32 v90, v90
    v_cvt_f32_i32 v91, v91
    v_cvt_f32_i32 v92, v92
    v_cvt_f32_i32 v93, v93
    v_cvt_f32_i32 v94, v94
    v_cvt_f32_i32 v95, v95
    v_pk_fma_f32 v[88:89], v[88:89], v[132:133], v[132:133] op_sel:[0,0,1] op_sel_hi:[1,0,1]
    v_pk_fma_f32 v[90:91], v[90:91], v[132:133], v[132:133] op_sel:[0,0,1] op_sel_hi:[1,0,1]
    v_pk_fma_f32 v[92:93], v[92:93], v[134:135], v[134:135] op_sel:[0,0,1] op_sel_hi:[1,0,1]
    v_pk_fma_f32 v[94:95], v[94:95], v[134:135], v[134:135] op_sel:[0,0,1] op_sel_hi:[1,0,1]
    v_cvt_pk_bf16_f32 v145, v88, v92
    v_cvt_pk_bf16_f32 v149, v89, v93
    v_cvt_pk_bf16_f32 v153, v90, v94
    v_cvt_pk_bf16_f32 v157, v91, v95
    s_waitcnt vmcnt(4)
    v_cvt_f32_i32 v96, v96
    v_cvt_f32_i32 v97, v97
    v_cvt_f32_i32 v98, v98
    v_cvt_f32_i32 v99, v99
    v_cvt_f32_i32 v100, v100
    v_cvt_f32_i32 v101, v101
    v_cvt_f32_i32 v102, v102
    v_cvt_f32_i32 v103, v103
    v_pk_fma_f32 v[96:97], v[96:97], v[136:137], v[136:137] op_sel:[0,0,1] op_sel_hi:[1,0,1]
    v_pk_fma_f32 v[98:99], v[98:99], v[136:137], v[136:137] op_sel:[0,0,1] op_sel_hi:[1,0,1]
    v_pk_fma_f32 v[100:101], v[100:101], v[138:139], v[138:139] op_sel:[0,0,1] op_sel_hi:[1,0,1]
    v_pk_fma_f32 v[102:103], v[102:103], v[138:139], v[138:139] op_sel:[0,0,1] op_sel_hi:[1,0,1]
    v_cvt_pk_bf16_f32 v146, v96, v100
    v_cvt_pk_bf16_f32 v150, v97, v101
    v_cvt_pk_bf16_f32 v154, v98, v102
    v_cvt_pk_bf16_f32 v158, v99, v103
    s_waitcnt vmcnt(2)
    v_cvt_f32_i32 v104, v104
    v_cvt_f32_i32 v105, v105
    v_cvt_f32_i32 v106, v106
    v_cvt_f32_i32 v107, v107
    v_cvt_f32_i32 v108, v108
    v_cvt_f32_i32 v109, v109
    v_cvt_f32_i32 v110, v110
    v_cvt_f32_i32 v111, v111
    v_pk_fma_f32 v[104:105], v[104:105], v[140:141], v[140:141] op_sel:[0,0,1] op_sel_hi:[1,0,1]
    v_pk_fma_f32 v[106:107], v[106:107], v[140:141], v[140:141] op_sel:[0,0,1] op_sel_hi:[1,0,1]
    v_pk_fma_f32 v[108:109], v[108:109], v[142:143], v[142:143] op_sel:[0,0,1] op_sel_hi:[1,0,1]
    v_pk_fma_f32 v[110:111], v[110:111], v[142:143], v[142:143] op_sel:[0,0,1] op_sel_hi:[1,0,1]
    v_cvt_pk_bf16_f32 v147, v104, v108
    global_store_dwordx4 v216, v[144:147], s[30:31] offset:0 sc1
    v_cvt_pk_bf16_f32 v151, v105, v109
    global_store_dwordx4 v216, v[148:151], s[30:31] offset:1024 sc1
    v_cvt_pk_bf16_f32 v155, v106, v110
    global_store_dwordx4 v216, v[152:155], s[30:31] offset:2048 sc1
    v_cvt_pk_bf16_f32 v159, v107, v111
    global_store_dwordx4 v216, v[156:159], s[30:31] offset:3072 sc1
    s_waitcnt vmcnt(4)
    s_branch L_join
L_qrole:
    v_min_u32 v236, 4, v0
    v_mul_u32_u24 v236, 1052672, v236
    global_load_dword v255, v236, s[30:31]
    s_bfe_u32 s32, s2, 0x20001
    s_and_b32 s33, s2, 1
    s_lshl_b32 s33, s33, 4
    s_lshr_b32 s40, s2, 4
    s_add_u32 s33, s33, s40
    s_bfe_u32 s34, s2, 0x10003
    s_mov_b32 s38, 0x05040100
    s_mov_b32 s39, 0x07060302
    v_lshrrev_b32 v209, 3, v0
    v_and_b32 v210, 7, v0
    s_lshr_b32 s42, s35, 1
    s_and_b32 s43, s35, 1
    s_mul_i32 s44, s35, 2304
    s_add_u32 s44, s44, 17408
    s_movk_i32 s45, 144
    v_lshl_add_u32 v213, v209, 4, s44
    v_mad_u32_u24 v213, v210, s45, v213
    v_lshl_add_u32 v214, v210, 4, s44
    v_mad_u32_u24 v214, v209, s45, v214
    s_lshr_b32 s40, s2, 6
    s_lshl_b32 s40, s40, 12
    s_add_u32 s40, s40, 0x1000
    s_add_u32 s49, s49, s40
    s_mov_b32 s40, s49
    s_lshl_b32 s44, s42, 12
    s_lshl_b32 s45, s43, 7
    s_add_u32 s45, s45, s44
    s_add_u32 s45, s45, s40
    v_lshl_add_u32 v215, v210, 4, s45
    v_lshl_add_u32 v215, v209, 8, v215
    s_getreg_b32 s53, hwreg(HW_REG_XCC_ID, 0, 4)
    s_mov_b32 s48, 0x3e0293ee
    s_lshl_b32 s46, s34, 1
    s_xor_b32 s46, s46, 2
    s_xor_b32 s46, s46, s35
    s_lshl_b32 s46, s46, 4
    s_lshl_b32 s47, s33, 6
    s_add_u32 s46, s46, s47
    v_add_u32 v224, s46, v209
    v_lshlrev_b32 v224, 8, v224
    v_lshl_add_u32 v224, v210, 4, v224
    s_lshl_b32 s47, s32, 19
    v_add_u32 v219, s47, v224
    s_lshl_b32 s46, s35, 12
    v_xor_b32 v217, v209, v210
    v_lshl_add_u32 v217, v217, 4, s46
    v_lshl_add_u32 v217, v210, 8, v217
    s_lshl_b32 s46, s34, 11
    v_add_u32 v224, s46, v224
    v_add_u32 v219, s46, v219
    v_xor_b32 v225, 0x800, v224
    v_xor_b32 v227, 0x800, v219
    s_lshl_b32 s46, s34, 7
    s_xor_b32 s47, s46, 0x80
    v_add_u32 v234, s47, v217
    v_add_u32 v217, s46, v217
    s_mov_b64 exec, 1
    global_load_dword v255, v219, s[4:5]
    global_load_dword v255, v224, s[18:19]
    global_load_dword v255, v224, s[20:21]
    s_mov_b64 exec, -1
    s_lshr_b32 s42, s35, 1
    s_and_b32 s43, s35, 1
    s_lshl_b32 s44, s42, 12
    v_xor_b32 v218, v212, v211
    v_lshl_add_u32 v218, v218, 4, s44
    v_lshl_add_u32 v218, v211, 8, v218
    v_xor_b32 v220, 0x1000, v218
    v_xor_b32 v232, 64, v218
    v_xor_b32 v233, 64, v220
    s_lshl_b32 s44, s32, 1
    s_add_u32 s44, s44, s34
    s_lshl_b32 s44, s44, 2
    s_add_u32 s44, s44, s35
    s_lshl_b32 s45, s44, 3
    v_add_u32 v221, s45, v0
    s_xor_b32 s45, s2, 8
    v_mov_b32 v222, s45
    v_cmp_gt_u32 vcc, 8, v0
    s_lshl_b32 s44, s44, 17
    s_lshl_b32 s54, s32, 12
    s_add_u32 s54, s54, 0x1000
    s_add_u32 s54, s54, s44
    s_add_u32 s54, s30, s54
    s_addc_u32 s55, s31, 0
    v_cndmask_b32 v221, v222, v221, vcc
    v_lshlrev_b32 v221, 11, v221
    v_add_u32 v1, 4259840, v221
    s_lshr_b32 s44, s44, 3
    s_add_u32 s44, s44, 4259840
    s_add_u32 s0, s30, s44
    s_addc_u32 s1, s31, 0
    v_lshlrev_b32 v244, 4, v0
    v_add_u32 v245, 0x1000, v244
    s_lshl_b32 s45, s43, 12
    s_add_u32 s45, s45, 0x2000
    v_add_u32 v246, s45, v244
    v_xor_b32 v247, 0x1000, v246
    v_mov_b32 v222, 26624
    v_mov_b32 v223, 0
    ds_write2_b32 v222, v223, v223 offset0:0 offset1:1
    s_add_u32 s56, s54, 0
    s_addc_u32 s57, s55, 0
    s_add_u32 s58, s54, 16384
    s_addc_u32 s59, s55, 0
    s_add_u32 s60, s54, 32768
    s_addc_u32 s61, s55, 0
    s_add_u32 s62, s54, 49152
    s_addc_u32 s63, s55, 0
    s_add_u32 s64, s54, 65536
    s_addc_u32 s65, s55, 0
    s_add_u32 s66, s54, 81920
    s_addc_u32 s67, s55, 0
    s_add_u32 s68, s54, 98304
    s_addc_u32 s69, s55, 0
    s_add_u32 s70, s54, 114688
    s_addc_u32 s71, s55, 0
    s_mul_i32 s40, s35, 8192
    s_add_u32 s40, s40, 32768
    v_lshl_add_u32 v4, v0, 4, s40
    s_xor_b32 s40, s35, 1
    s_mul_i32 s40, s40, 8192
    s_add_u32 s40, s40, 32768
    v_lshl_add_u32 v5, v0, 4, s40
    s_xor_b32 s40, s35, 2
    s_mul_i32 s40, s40, 8192
    s_add_u32 s40, s40, 32768
    v_lshl_add_u32 v6, v0, 4, s40
    s_xor_b32 s40, s35, 3
    s_mul_i32 s40, s40, 8192
    s_add_u32 s40, s40, 32776
    v_lshl_add_u32 v7, v0, 4, s40
    v_and_b32 v221, 8, v0
    v_xor_b32 v5, v5, v221
    v_xor_b32 v7, v7, v221
    s_lshl_b32 s40, s32, 5
    s_add_u32 s40, s40, s33
    s_lshl_b32 s40, s40, 1
    s_add_u32 s40, s40, s34
    s_lshl_b32 s41, s40, 2
    s_add_u32 s41, s41, s35
    s_lshl_b32 s41, s41, 9
    s_add_u32 s41, s41, 5242880
    v_lshl_add_u32 v11, v0, 3, s41
    s_lshl_b32 s40, s40, 13
    s_lshr_b32 s41, s35, 1
    s_lshl_b32 s41, s41, 12
    s_add_u32 s40, s40, s41
    s_and_b32 s41, s35, 1
    s_lshl_b32 s41, s41, 7
    s_add_u32 s40, s40, s41
    v_lshl_add_u32 v12, v209, 8, s40
    v_lshl_add_u32 v12, v210, 4, v12
    v_xor_b32 v2, 0x2000, v12
    v_min_u32 v3, 15, v0
    v_lshl_add_u32 v3, v3, 8, s40
    s_add_u32 s6, s26, s40
    s_addc_u32 s7, s27, 0
    s_xor_b32 s40, s2, 8
    s_lshl_b32 s40, s40, 11
    s_add_u32 s40, s40, 4259840
    s_add_u32 s10, s30, s40
    s_addc_u32 s11, s31, 0
    s_lshl_b32 s40, s35, 6
    s_cmp_eq_u32 s2, 0
    s_cselect_b32 s40, s40, s2
    s_cselect_b32 s41, 63, 0
    v_and_b32 v8, s41, v0
    v_add_u32 v8, s40, v8
    v_lshlrev_b32 v8, 11, v8
    v_add_u32 v8, 4259840, v8
    v_lshrrev_b32 v221, 2, v212
    v_cmp_eq_u32 vcc, v221, v211
    v_and_b32 v221, 1, v0
    v_lshlrev_b32 v221, 4, v221
    v_mov_b32 v222, 0x3f80
    v_lshlrev_b32 v221, v221, v222
    v_cndmask_b32 v221, 0, v221, vcc
    v_and_b32 v222, 2, v0
    v_cmp_eq_u32 vcc, 0, v222
    v_accvgpr_write_b32 a66, 0
    v_accvgpr_write_b32 a67, 0
    v_cndmask_b32 v222, 0, v221, vcc
    v_cndmask_b32 v223, v221, v223, vcc
    v_accvgpr_write_b32 a68, 0
    v_accvgpr_write_b32 a69, 0
    v_accvgpr_write_b32 a64, v222
    v_accvgpr_write_b32 a65, v223
    v_accvgpr_write_b32 a70, v222
    v_accvgpr_write_b32 a71, v223
    v_accvgpr_write_b32 a72, v222
    v_accvgpr_write_b32 a73, v223
    v_lshlrev_b32 v221, 2, v211
    v_sub_u32 v221, v212, v221
    v_mov_b32 v223, 0x3f803f80
    v_cmp_eq_u32 vcc, 0, v221
    s_nop 1
    v_cndmask_b32 v222, 0, v223, vcc
    v_accvgpr_write_b32 a76, v222
    v_accvgpr_write_b32 a77, v222
    v_accvgpr_write_b32 a78, v222
    v_accvgpr_write_b32 a79, v222
    v_cmp_eq_u32 vcc, 1, v221
    s_nop 1
    v_cndmask_b32 v222, 0, v223, vcc
    v_accvgpr_write_b32 a80, v222
    v_accvgpr_write_b32 a81, v222
    v_accvgpr_write_b32 a82, v222
    v_accvgpr_write_b32 a83, v222
    v_cmp_eq_u32 vcc, 2, v221
    s_nop 1
    v_cndmask_b32 v222, 0, v223, vcc
    v_accvgpr_write_b32 a84, v222
    v_accvgpr_write_b32 a85, v222
    v_accvgpr_write_b32 a86, v222
    v_accvgpr_write_b32 a87, v222
    v_cmp_eq_u32 vcc, 3, v221
    s_nop 1
    v_cndmask_b32 v222, 0, v223, vcc
    v_accvgpr_write_b32 a88, v222
    v_accvgpr_write_b32 a89, v222
    v_accvgpr_write_b32 a90, v222
    v_accvgpr_write_b32 a91, v222
    s_mov_b64 exec, 1
    global_load_dword v255, v3, s[26:27]
    global_load_dword v255, v11, s[30:31]
    s_mov_b64 exec, -1
    s_waitcnt vmcnt(12)
    v_cvt_f32_i32 v16, v16
    v_cvt_f32_i32 v17, v17
    v_cvt_f32_i32 v18, v18
    v_cvt_f32_i32 v19, v19
    v_cvt_f32_i32 v20, v20
    v_cvt_f32_i32 v21, v21
    v_cvt_f32_i32 v22, v22
    v_cvt_f32_i32 v23, v23
    v_cvt_f32_i32 v24, v24
    v_cvt_f32_i32 v25, v25
    v_cvt_f32_i32 v26, v26
    v_cvt_f32_i32 v27, v27
    v_cvt_f32_i32 v28, v28
    v_cvt_f32_i32 v29, v29
    v_cvt_f32_i32 v30, v30
    v_cvt_f32_i32 v31, v31
    s_waitcnt vmcnt(10)
    v_lshlrev_b32 v50, 16, v48
    v_and_b32 v52, 0xffff0000, v48
    v_lshlrev_b32 v51, 16, v49
    v_and_b32 v53, 0xffff0000, v49
    v_mul_f32 v50, s48, v50
    v_mul_f32 v52, s48, v52
    v_mul_f32_e64 v51, -v51, v50
    v_mul_f32_e64 v53, -v53, v52
    v_pk_fma_f32 v[16:17], v[16:17], v[50:51], v[50:51] op_sel:[0,0,1] op_sel_hi:[1,0,1]
    v_pk_fma_f32 v[18:19], v[18:19], v[50:51], v[50:51] op_sel:[0,0,1] op_sel_hi:[1,0,1]
    v_pk_fma_f32 v[20:21], v[20:21], v[50:51], v[50:51] op_sel:[0,0,1] op_sel_hi:[1,0,1]
    v_pk_fma_f32 v[22:23], v[22:23], v[50:51], v[50:51] op_sel:[0,0,1] op_sel_hi:[1,0,1]
    v_pk_fma_f32 v[24:25], v[24:25], v[52:53], v[52:53] op_sel:[0,0,1] op_sel_hi:[1,0,1]
    v_pk_fma_f32 v[26:27], v[26:27], v[52:53], v[52:53] op_sel:[0,0,1] op_sel_hi:[1,0,1]
    v_pk_fma_f32 v[28:29], v[28:29], v[52:53], v[52:53] op_sel:[0,0,1] op_sel_hi:[1,0,1]
    v_pk_fma_f32 v[30:31], v[30:31], v[52:53], v[52:53] op_sel:[0,0,1] op_sel_hi:[1,0,1]
    v_cvt_pk_bf16_f32 v16, v16, v24
    v_cvt_pk_bf16_f32 v17, v17, v25
    v_cvt_pk_bf16_f32 v18, v18, v26
    v_cvt_pk_bf16_f32 v19, v19, v27
    v_cvt_pk_bf16_f32 v20, v20, v28
    v_cvt_pk_bf16_f32 v21, v21, v29
    v_cvt_pk_bf16_f32 v22, v22, v30
    v_cvt_pk_bf16_f32 v23, v23, v31
    s_waitcnt lgkmcnt(0)
    s_add_u32 s37, s37, 0x9e3779b1
    s_lshl_b32 s40, s2, 11
    s_add_u32 s40, s40, 4259840
    s_mov_b32 s41, s37
    s_mov_b32 s24, s37
    s_mov_b32 s25, s37
    s_waitcnt vmcnt(8)
    v_perm_b32 v56, v40, v32, s38
    v_perm_b32 v57, v40, v32, s39
    v_perm_b32 v58, v41, v33, s38
    v_perm_b32 v59, v41, v33, s39
    v_perm_b32 v60, v42, v34, s38
    v_perm_b32 v61, v42, v34, s39
    v_perm_b32 v62, v43, v35, s38
    v_perm_b32 v63, v43, v35, s39
    v_dot2_f32_bf16 v56, v16, v56, 0 neg_hi:[0,1,0]
    v_dot2_f32_bf16 v57, v17, v57, 0 neg_hi:[0,1,0]
    v_dot2_f32_bf16 v58, v18, v58, 0 neg_hi:[0,1,0]
    v_dot2_f32_bf16 v59, v19, v59, 0 neg_hi:[0,1,0]
    v_dot2_f32_bf16 v60, v20, v60, 0 neg_hi:[0,1,0]
    v_dot2_f32_bf16 v61, v21, v61, 0 neg_hi:[0,1,0]
    v_dot2_f32_bf16 v62, v22, v62, 0 neg_hi:[0,1,0]
    v_dot2_f32_bf16 v63, v23, v63, 0 neg_hi:[0,1,0]
    v_cvt_pk_bf16_f32 v56, v56, v57
    v_cvt_pk_bf16_f32 v57, v58, v59
    v_cvt_pk_bf16_f32 v58, v60, v61
    v_cvt_pk_bf16_f32 v59, v62, v63
    ds_write_b128 v213, v[56:59] offset:0
    ds_read_b128 v[72:75], v214 offset:0
    s_waitcnt vmcnt(6)
    v_perm_b32 v64, v36, v44, s38
    v_perm_b32 v65, v36, v44, s39
    v_perm_b32 v66, v37, v45, s38
    v_perm_b32 v67, v37, v45, s39
    v_perm_b32 v68, v38, v46, s38
    v_perm_b32 v69, v38, v46, s39
    v_perm_b32 v70, v39, v47, s38
    v_perm_b32 v71, v39, v47, s39
    v_dot2_f32_bf16 v64, v16, v64, 0
    v_dot2_f32_bf16 v65, v17, v65, 0
    v_dot2_f32_bf16 v66, v18, v66, 0
    v_dot2_f32_bf16 v67, v19, v67, 0
    v_dot2_f32_bf16 v68, v20, v68, 0
    v_dot2_f32_bf16 v69, v21, v69, 0
    v_dot2_f32_bf16 v70, v22, v70, 0
    v_dot2_f32_bf16 v71, v23, v71, 0
    s_waitcnt lgkmcnt(0)
    global_store_dwordx4 v215, v[72:75], s[30:31] sc1
    v_cvt_pk_bf16_f32 v64, v64, v65
    v_cvt_pk_bf16_f32 v65, v66, v67
    v_cvt_pk_bf16_f32 v66, v68, v69
    v_cvt_pk_bf16_f32 v67, v70, v71
    ds_write_b128 v213, v[64:67] offset:1152
    ds_read_b128 v[76:79], v214 offset:1152
    v_lshl_add_u32 v226, v0, 4, s40
    v_mov_b32 v228, s41
    v_mov_b32 v229, s37
    v_mov_b32 v230, s41
    v_mov_b32 v231, s41
    s_waitcnt lgkmcnt(0)
    global_store_dwordx4 v215, v[76:79], s[30:31] offset:2048 sc1
    s_mov_b64 exec, 0
    s_branch L_hook0
L_hookdone:
    s_mov_b64 exec, -1
    s_waitcnt vmcnt(0)
    s_branch L_join
L_second:
    s_cbranch_execz L_bump
    s_load_dword s40, s[0:1], 1152
    s_load_dword s41, s[0:1], 3200
    s_waitcnt vmcnt(0)
    v_perm_b32 v16, v188, v184, s38
    v_perm_b32 v17, v188, v184, s39
    v_perm_b32 v18, v189, v185, s38
    v_perm_b32 v19, v189, v185, s39
    v_perm_b32 v20, v190, v186, s38
    v_perm_b32 v21, v190, v186, s39
    v_perm_b32 v22, v191, v187, s38
    v_perm_b32 v23, v191, v187, s39
    v_perm_b32 v24, v200, v192, s38
    v_perm_b32 v25, v200, v192, s39
    v_perm_b32 v26, v201, v193, s38
    v_perm_b32 v27, v201, v193, s39
    v_perm_b32 v28, v202, v194, s38
    v_perm_b32 v29, v202, v194, s39
    v_perm_b32 v30, v203, v195, s38
    v_perm_b32 v31, v203, v195, s39
    v_dot2_f32_bf16 v24, v16, v24, 0 neg_hi:[0,1,0]
    v_dot2_f32_bf16 v25, v17, v25, 0 neg_hi:[0,1,0]
    v_dot2_f32_bf16 v26, v18, v26, 0 neg_hi:[0,1,0]
    v_dot2_f32_bf16 v27, v19, v27, 0 neg_hi:[0,1,0]
    v_dot2_f32_bf16 v28, v20, v28, 0 neg_hi:[0,1,0]
    v_dot2_f32_bf16 v29, v21, v29, 0 neg_hi:[0,1,0]
    v_dot2_f32_bf16 v30, v22, v30, 0 neg_hi:[0,1,0]
    v_dot2_f32_bf16 v31, v23, v31, 0 neg_hi:[0,1,0]
    v_cvt_pk_bf16_f32 v48, v24, v25
    v_cvt_pk_bf16_f32 v49, v26, v27
    v_cvt_pk_bf16_f32 v50, v28, v29
    v_cvt_pk_bf16_f32 v51, v30, v31
    ds_write_b128 v234, v[48:51]
    v_perm_b32 v32, v196, v204, s38
    v_perm_b32 v33, v196, v204, s39
    v_perm_b32 v34, v197, v205, s38
    v_perm_b32 v35, v197, v205, s39
    v_perm_b32 v36, v198, v206, s38
    v_perm_b32 v37, v198, v206, s39
    v_perm_b32 v38, v199, v207, s38
    v_perm_b32 v39, v199, v207, s39
    v_dot2_f32_bf16 v32, v16, v32, 0
    v_dot2_f32_bf16 v33, v17, v33, 0
    v_dot2_f32_bf16 v34, v18, v34, 0
    v_dot2_f32_bf16 v35, v19, v35, 0
    v_dot2_f32_bf16 v36, v20, v36, 0
    v_dot2_f32_bf16 v37, v21, v37, 0
    v_dot2_f32_bf16 v38, v22, v38, 0
    v_dot2_f32_bf16 v39, v23, v39, 0
    v_cvt_pk_bf16_f32 v52, v32, v33
    v_cvt_pk_bf16_f32 v53, v34, v35
    v_cvt_pk_bf16_f32 v54, v36, v37
    v_cvt_pk_bf16_f32 v55, v38, v39
    ds_write_b128 v234, v[52:55] offset:2048
    s_waitcnt lgkmcnt(0)
    s_cmp_lg_u32 s40, s37
    s_cbranch_scc1 L_kspin01
    s_cmp_lg_u32 s41, s37
    s_cbranch_scc1 L_kspin01
L_kdone01:
    global_load_dwordx4 a[92:95], v244, s[56:57] offset:0 sc1
    global_load_dwordx4 a[96:99], v244, s[56:57] offset:1024 sc1
    global_load_dwordx4 a[100:103], v244, s[56:57] offset:2048 sc1
    global_load_dwordx4 a[104:107], v244, s[56:57] offset:3072 sc1
    global_load_dwordx4 a[108:111], v245, s[56:57] offset:0 sc1
    global_load_dwordx4 a[112:115], v245, s[56:57] offset:1024 sc1
    global_load_dwordx4 a[116:119], v245, s[56:57] offset:2048 sc1
    global_load_dwordx4 a[120:123], v245, s[56:57] offset:3072 sc1
    global_load_dwordx4 a[124:127], v244, s[58:59] offset:0 sc1
    global_load_dwordx4 a[128:131], v244, s[58:59] offset:1024 sc1
    global_load_dwordx4 a[132:135], v244, s[58:59] offset:2048 sc1
    global_load_dwordx4 a[136:139], v244, s[58:59] offset:3072 sc1
    global_load_dwordx4 a[140:143], v245, s[58:59] offset:0 sc1
    s_branch L_secondback
L_kspin234:
    s_mov_b32 s46, 0x200000
    v_add_u32 v14, 128, v1
    v_add_u32 v15, 896, v1
L_kspinx234:
    v_add_u32 v14, 128, v14
    v_min_u32 v14, v14, v15
    global_load_dword v10, v14, s[30:31] offset:1024 sc1
    s_sub_u32 s46, s46, 1
    s_cbranch_scc1 L_kdone234
    s_waitcnt vmcnt(0)
    v_cmp_eq_u32 vcc, s37, v10
    s_and_b32 s48, vcc_lo, 28
    s_bcnt1_i32_b32 s49, s48
    s_cmp_lt_u32 s49, 3
    s_cbranch_scc1 L_kspinx234
    s_branch L_kdone234
L_kspin01:
    s_mov_b32 s46, 0x200000
    v_add_u32 v14, 128, v1
    v_add_u32 v15, 896, v1
L_kspinx01:
    v_add_u32 v14, 128, v14
    v_min_u32 v14, v14, v15
    global_load_dword v10, v14, s[30:31] offset:1024 sc1
    s_sub_u32 s46, s46, 1
    s_cbranch_scc1 L_kdone01
    s_waitcnt vmcnt(0)
    v_cmp_eq_u32 vcc, s37, v10
    s_and_b32 s48, vcc_lo, 3
    s_bcnt1_i32_b32 s49, s48
    s_cmp_lt_u32 s49, 2
    s_cbranch_scc1 L_kspinx01
    s_branch L_kdone01
L_spin:
    s_mov_b32 s46, 0x200000
    s_mov_b32 s47, 0
L_spin1:
    s_add_u32 s47, s47, 128
    s_min_u32 s47, s47, 896
    v_add_u32 v14, s47, v1
    v_add_u32 v15, s47, v8
    global_load_dword v10, v14, s[30:31] sc1
    global_load_dword v9, v15, s[30:31] sc1
    s_sub_u32 s46, s46, 1
    s_cbranch_scc1 L_spinback
    s_waitcnt vmcnt(0)
    v_xor_b32 v13, s37, v10
    v_xor_b32 v9, s37, v9
    v_or_b32 v13, v13, v9
    v_cmp_lt_u32 vcc, 15, v13
    s_cbranch_vccnz L_spin1
    v_readlane_b32 s36, v10, 32
    s_branch L_spinback
.p2align 12
L_join:
L_hook0:
    s_cbranch_execz L_hook1
    s_barrier
    s_cmp_lg_u32 s35, 2
    s_cbranch_scc1 L_nokflag
    global_store_dwordx4 v226, v[228:231], s[30:31] offset:1024 sc1
L_nokflag:
    global_load_dwordx4 v[160:163], v219, s[4:5] offset:0
    global_load_dwordx4 v[164:167], v219, s[4:5] offset:128
    global_load_dwordx4 v[168:171], v224, s[18:19] offset:0
    global_load_dwordx4 v[176:179], v224, s[20:21] offset:0
    global_load_dwordx4 v[172:175], v224, s[18:19] offset:128
    global_load_dwordx4 v[180:183], v224, s[20:21] offset:128
    s_barrier
    global_load_dwordx4 v[184:187], v227, s[4:5] offset:0
    global_load_dwordx4 v[188:191], v227, s[4:5] offset:128
    global_load_dwordx4 v[192:195], v225, s[18:19] offset:0
    global_load_dwordx4 v[200:203], v225, s[20:21] offset:0
    global_load_dwordx4 v[196:199], v225, s[18:19] offset:128
    global_load_dwordx4 v[204:207], v225, s[20:21] offset:128
    s_waitcnt vmcnt(12)
    s_barrier
    s_cmp_lg_u32 s35, 0
    s_cbranch_scc1 L_noflag
    global_store_dwordx4 v226, v[228:231], s[30:31] sc1
L_noflag:
    s_waitcnt vmcnt(10)
    s_load_dword s40, s[0:1], 1024
    s_load_dword s41, s[0:1], 3072
    s_waitcnt vmcnt(8)
    v_perm_b32 v16, v164, v160, s38
    v_perm_b32 v17, v164, v160, s39
    v_perm_b32 v18, v165, v161, s38
    v_perm_b32 v19, v165, v161, s39
    v_perm_b32 v20, v166, v162, s38
    v_perm_b32 v21, v166, v162, s39
    v_perm_b32 v22, v167, v163, s38
    v_perm_b32 v23, v167, v163, s39
    v_perm_b32 v24, v176, v168, s38
    v_perm_b32 v25, v176, v168, s39
    v_perm_b32 v26, v177, v169, s38
    v_perm_b32 v27, v177, v169, s39
    v_perm_b32 v28, v178, v170, s38
    v_perm_b32 v29, v178, v170, s39
    v_perm_b32 v30, v179, v171, s38
    v_perm_b32 v31, v179, v171, s39
    v_dot2_f32_bf16 v24, v16, v24, 0 neg_hi:[0,1,0]
    v_dot2_f32_bf16 v25, v17, v25, 0 neg_hi:[0,1,0]
    v_dot2_f32_bf16 v26, v18, v26, 0 neg_hi:[0,1,0]
    v_dot2_f32_bf16 v27, v19, v27, 0 neg_hi:[0,1,0]
    v_dot2_f32_bf16 v28, v20, v28, 0 neg_hi:[0,1,0]
    v_dot2_f32_bf16 v29, v21, v29, 0 neg_hi:[0,1,0]
    v_dot2_f32_bf16 v30, v22, v30, 0 neg_hi:[0,1,0]
    v_dot2_f32_bf16 v31, v23, v31, 0 neg_hi:[0,1,0]
    v_cvt_pk_bf16_f32 v40, v24, v25
    v_cvt_pk_bf16_f32 v41, v26, v27
    v_cvt_pk_bf16_f32 v42, v28, v29
    v_cvt_pk_bf16_f32 v43, v30, v31
    ds_write_b128 v217, v[40:43] offset:0
    s_waitcnt vmcnt(6)
    v_perm_b32 v32, v172, v180, s38
    v_perm_b32 v33, v172, v180, s39
    v_perm_b32 v34, v173, v181, s38
    v_perm_b32 v35, v173, v181, s39
    v_perm_b32 v36, v174, v182, s38
    v_perm_b32 v37, v174, v182, s39
    v_perm_b32 v38, v175, v183, s38
    v_perm_b32 v39, v175, v183, s39
    v_dot2_f32_bf16 v32, v16, v32, 0
    v_dot2_f32_bf16 v33, v17, v33, 0
    v_dot2_f32_bf16 v34, v18, v34, 0
    v_dot2_f32_bf16 v35, v19, v35, 0
    v_dot2_f32_bf16 v36, v20, v36, 0
    v_dot2_f32_bf16 v37, v21, v37, 0
    v_dot2_f32_bf16 v38, v22, v38, 0
    v_dot2_f32_bf16 v39, v23, v39, 0
    v_cvt_pk_bf16_f32 v44, v32, v33
    v_cvt_pk_bf16_f32 v45, v34, v35
    v_cvt_pk_bf16_f32 v46, v36, v37
    v_cvt_pk_bf16_f32 v47, v38, v39
    ds_write_b128 v217, v[44:47] offset:2048
    s_waitcnt lgkmcnt(0)
    s_load_dword s42, s[0:1], 5120
    s_load_dword s43, s[0:1], 7168
    s_load_dword s44, s[0:1], 9216
    s_cmp_lg_u32 s40, s37
    s_cbranch_scc1 L_second
    s_cmp_lg_u32 s41, s37
    s_cbranch_scc1 L_second
    global_load_dwordx4 a[92:95], v244, s[56:57] offset:0 sc1
    global_load_dwordx4 a[96:99], v244, s[56:57] offset:1024 sc1
    global_load_dwordx4 a[100:103], v244, s[56:57] offset:2048 sc1
    global_load_dwordx4 a[104:107], v244, s[56:57] offset:3072 sc1
    global_load_dwordx4 a[108:111], v245, s[56:57] offset:0 sc1
    global_load_dwordx4 a[112:115], v245, s[56:57] offset:1024 sc1
    global_load_dwordx4 a[116:119], v245, s[56:57] offset:2048 sc1
    global_load_dwordx4 a[120:123], v245, s[56:57] offset:3072 sc1
    s_waitcnt vmcnt(10)
    v_perm_b32 v16, v188, v184, s38
    v_perm_b32 v17, v188, v184, s39
    v_perm_b32 v18, v189, v185, s38
    v_perm_b32 v19, v189, v185, s39
    v_perm_b32 v20, v190, v186, s38
    v_perm_b32 v21, v190, v186, s39
    v_perm_b32 v22, v191, v187, s38
    v_perm_b32 v23, v191, v187, s39
    v_perm_b32 v24, v200, v192, s38
    global_load_dwordx4 a[124:127], v244, s[58:59] offset:0 sc1
    v_perm_b32 v25, v200, v192, s39
    v_perm_b32 v26, v201, v193, s38
    v_perm_b32 v27, v201, v193, s39
    v_perm_b32 v28, v202, v194, s38
    v_perm_b32 v29, v202, v194, s39
    v_perm_b32 v30, v203, v195, s38
    v_perm_b32 v31, v203, v195, s39
    v_dot2_f32_bf16 v24, v16, v24, 0 neg_hi:[0,1,0]
    v_dot2_f32_bf16 v25, v17, v25, 0 neg_hi:[0,1,0]
    global_load_dwordx4 a[128:131], v244, s[58:59] offset:1024 sc1
    v_dot2_f32_bf16 v26, v18, v26, 0 neg_hi:[0,1,0]
    v_dot2_f32_bf16 v27, v19, v27, 0 neg_hi:[0,1,0]
    v_dot2_f32_bf16 v28, v20, v28, 0 neg_hi:[0,1,0]
    v_dot2_f32_bf16 v29, v21, v29, 0 neg_hi:[0,1,0]
    v_dot2_f32_bf16 v30, v22, v30, 0 neg_hi:[0,1,0]
    v_dot2_f32_bf16 v31, v23, v31, 0 neg_hi:[0,1,0]
    v_cvt_pk_bf16_f32 v48, v24, v25
    v_cvt_pk_bf16_f32 v49, v26, v27
    v_cvt_pk_bf16_f32 v50, v28, v29
    global_load_dwordx4 a[132:135], v244, s[58:59] offset:2048 sc1
    v_cvt_pk_bf16_f32 v51, v30, v31
    ds_write_b128 v234, v[48:51]
    s_waitcnt vmcnt(11)
    v_perm_b32 v32, v196, v204, s38
    v_perm_b32 v33, v196, v204, s39
    v_perm_b32 v34, v197, v205, s38
    v_perm_b32 v35, v197, v205, s39
    v_perm_b32 v36, v198, v206, s38
    v_perm_b32 v37, v198, v206, s39
    global_load_dwordx4 a[136:139], v244, s[58:59] offset:3072 sc1
    v_perm_b32 v38, v199, v207, s38
    v_perm_b32 v39, v199, v207, s39
    v_dot2_f32_bf16 v32, v16, v32, 0
    v_dot2_f32_bf16 v33, v17, v33, 0
    v_dot2_f32_bf16 v34, v18, v34, 0
    v_dot2_f32_bf16 v35, v19, v35, 0
    v_dot2_f32_bf16 v36, v20, v36, 0
    v_dot2_f32_bf16 v37, v21, v37, 0
    v_dot2_f32_bf16 v38, v22, v38, 0
    global_load_dwordx4 a[140:143], v245, s[58:59] offset:0 sc1
    v_dot2_f32_bf16 v39, v23, v39, 0
    v_cvt_pk_bf16_f32 v52, v32, v33
    v_cvt_pk_bf16_f32 v53, v34, v35
    v_cvt_pk_bf16_f32 v54, v36, v37
    v_cvt_pk_bf16_f32 v55, v38, v39
    ds_write_b128 v234, v[52:55] offset:2048
L_secondback:
    s_waitcnt lgkmcnt(0)
    s_cmp_lg_u32 s42, s37
    s_cbranch_scc1 L_kspin234
    s_cmp_lg_u32 s43, s37
    s_cbranch_scc1 L_kspin234
    s_cmp_lg_u32 s44, s37
    s_cbranch_scc1 L_kspin234
L_kdone234:
    s_waitcnt lgkmcnt(0)
    s_barrier
    ds_read_b128 a[0:3], v218 offset:0
    ds_read_b128 a[4:7], v232 offset:1024
    ds_read_b128 a[8:11], v218 offset:2048
    ds_read_b128 a[12:15], v232 offset:3072
    ds_read_b128 a[16:19], v220 offset:0
    ds_read_b128 a[20:23], v233 offset:1024
    ds_read_b128 a[24:27], v220 offset:2048
    ds_read_b128 a[28:31], v233 offset:3072
    global_load_dwordx4 a[144:147], v245, s[58:59] offset:1024 sc1
    global_load_dwordx4 a[148:151], v245, s[58:59] offset:2048 sc1
    global_load_dwordx4 a[152:155], v245, s[58:59] offset:3072 sc1
    global_load_dwordx4 a[156:159], v244, s[60:61] offset:0 sc1
    global_load_dwordx4 a[160:163], v244, s[60:61] offset:1024 sc1
    s_waitcnt lgkmcnt(4)
    s_waitcnt vmcnt(17)
.p2align 3
    v_mfma_f32_16x16x32_bf16 v[144:147], a[92:95], a[0:3], 0
    s_waitcnt vmcnt(16)
    ds_read_b128 a[32:35], v218 offset:8192
    ds_read_b128 a[36:39], v232 offset:9216
    v_mfma_f32_16x16x32_bf16 v[144:147], a[96:99], a[4:7], v[144:147]
    s_waitcnt vmcnt(15)
    ds_read_b128 a[40:43], v218 offset:10240
    ds_read_b128 a[44:47], v232 offset:11264
    v_mfma_f32_16x16x32_bf16 v[144:147], a[100:103], a[8:11], v[144:147]
    s_waitcnt vmcnt(14)
    ds_read_b128 a[48:51], v220 offset:8192
    ds_read_b128 a[52:55], v233 offset:9216
    v_mfma_f32_16x16x32_bf16 v[144:147], a[104:107], a[12:15], v[144:147]
    ds_read_b128 a[56:59], v220 offset:10240
    ds_read_b128 a[60:63], v233 offset:11264
    s_waitcnt lgkmcnt(8)
    global_load_dwordx4 a[164:167], v244, s[60:61] offset:2048 sc1
    v_mfma_f32_16x16x32_bf16 v[148:151], a[104:107], a[28:31], 0
    v_mfma_f32_16x16x32_bf16 v[148:151], a[100:103], a[24:27], v[148:151]
    v_mfma_f32_16x16x32_bf16 v[148:151], a[96:99], a[20:23], v[148:151]
    v_mfma_f32_16x16x32_bf16 v[148:151], a[92:95], a[16:19], v[148:151]
    s_waitcnt lgkmcnt(4)
    global_load_dwordx4 a[168:171], v244, s[60:61] offset:3072 sc1
    v_mfma_f32_16x16x32_bf16 v[152:155], a[92:95], a[32:35], 0
    v_exp_f32 v144, v144
    v_mfma_f32_16x16x32_bf16 v[152:155], a[96:99], a[36:39], v[152:155]
    v_exp_f32 v145, v145
    v_mfma_f32_16x16x32_bf16 v[152:155], a[100:103], a[40:43], v[152:155]
    v_exp_f32 v146, v146
    v_mfma_f32_16x16x32_bf16 v[152:155], a[104:107], a[44:47], v[152:155]
    s_waitcnt lgkmcnt(0)
    global_load_dwordx4 a[172:175], v245, s[60:61] offset:0 sc1
    v_cvt_pk_bf16_f32 v144, v144, v145
    v_mfma_f32_16x16x32_bf16 v[156:159], a[104:107], a[60:63], 0
    v_exp_f32 v147, v147
    v_mfma_f32_16x16x32_bf16 v[156:159], a[100:103], a[56:59], v[156:159]
    v_exp_f32 v148, v148
    v_mfma_f32_16x16x32_bf16 v[156:159], a[96:99], a[52:55], v[156:159]
    v_exp_f32 v149, v149
    v_mfma_f32_16x16x32_bf16 v[156:159], a[92:95], a[48:51], v[156:159]
    s_waitcnt vmcnt(13)
    global_load_dwordx4 a[176:179], v245, s[60:61] offset:1024 sc1
    v_cvt_pk_bf16_f32 v145, v146, v147
    v_mfma_f32_16x16x32_bf16 v[160:163], a[108:111], a[0:3], 0
    v_exp_f32 v150, v150
    v_mfma_f32_16x16x32_bf16 v[160:163], a[112:115], a[4:7], v[160:163]
    v_exp_f32 v151, v151
    v_mfma_f32_16x16x32_bf16 v[160:163], a[116:119], a[8:11], v[160:163]
    v_cvt_pk_bf16_f32 v148, v148, v149
    v_cvt_pk_bf16_f32 v149, v150, v151
    v_mfma_f32_16x16x32_bf16 v[160:163], a[120:123], a[12:15], v[160:163]
    global_load_dwordx4 a[180:183], v245, s[60:61] offset:2048 sc1
    v_mfma_f32_16x16x32_bf16 v[164:167], a[120:123], a[28:31], 0
    v_exp_f32 v152, v152
    v_mfma_f32_16x16x32_bf16 v[164:167], a[116:119], a[24:27], v[164:167]
    v_exp_f32 v153, v153
    v_mfma_f32_16x16x32_bf16 v[164:167], a[112:115], a[20:23], v[164:167]
    v_exp_f32 v154, v154
    v_mfma_f32_16x16x32_bf16 v[164:167], a[108:111], a[16:19], v[164:167]
    global_load_dwordx4 a[184:187], v245, s[60:61] offset:3072 sc1
    v_cvt_pk_bf16_f32 v152, v152, v153
    v_mfma_f32_16x16x32_bf16 v[168:171], a[108:111], a[32:35], 0
    v_exp_f32 v160, v160
    v_mfma_f32_16x16x32_bf16 v[168:171], a[112:115], a[36:39], v[168:171]
    v_exp_f32 v161, v161
    v_mfma_f32_16x16x32_bf16 v[168:171], a[116:119], a[40:43], v[168:171]
    v_exp_f32 v162, v162
    v_mfma_f32_16x16x32_bf16 v[168:171], a[120:123], a[44:47], v[168:171]
    global_load_dwordx4 a[188:191], v244, s[62:63] offset:0 sc1
    v_cvt_pk_bf16_f32 v146, v160, v161
    v_mfma_f32_16x16x32_bf16 v[172:175], a[120:123], a[60:63], 0
    v_exp_f32 v163, v163
    v_mfma_f32_16x16x32_bf16 v[172:175], a[116:119], a[56:59], v[172:175]
    v_exp_f32 v164, v164
    v_mfma_f32_16x16x32_bf16 v[172:175], a[112:115], a[52:55], v[172:175]
    v_exp_f32 v165, v165
    v_mfma_f32_16x16x32_bf16 v[172:175], a[108:111], a[48:51], v[172:175]
    s_waitcnt vmcnt(13)
    global_load_dwordx4 a[192:195], v244, s[62:63] offset:1024 sc1
    v_cvt_pk_bf16_f32 v147, v162, v163
    v_mfma_f32_16x16x32_bf16 v[176:179], a[124:127], a[0:3], 0
    v_exp_f32 v166, v166
    v_mfma_f32_16x16x32_bf16 v[176:179], a[128:131], a[4:7], v[176:179]
    v_exp_f32 v167, v167
    v_mfma_f32_16x16x32_bf16 v[176:179], a[132:135], a[8:11], v[176:179]
    v_cvt_pk_bf16_f32 v150, v164, v165
    v_cvt_pk_bf16_f32 v151, v166, v167
    v_mfma_f32_16x16x32_bf16 v[176:179], a[136:139], a[12:15], v[176:179]
    global_load_dwordx4 a[196:199], v244, s[62:63] offset:2048 sc1
    v_mfma_f32_16x16x32_bf16 v[180:183], a[136:139], a[28:31], 0
    v_exp_f32 v155, v155
    v_mfma_f32_16x16x32_bf16 v[180:183], a[132:135], a[24:27], v[180:183]
    v_exp_f32 v168, v168
    v_mfma_f32_16x16x32_bf16 v[180:183], a[128:131], a[20:23], v[180:183]
    v_exp_f32 v169, v169
    v_mfma_f32_16x16x32_bf16 v[180:183], a[124:127], a[16:19], v[180:183]
    global_load_dwordx4 a[200:203], v244, s[62:63] offset:3072 sc1
    v_cvt_pk_bf16_f32 v153, v154, v155
    v_mfma_f32_16x16x32_bf16 v[184:187], a[124:127], a[32:35], 0
    v_exp_f32 v170, v170
    v_mfma_f32_16x16x32_bf16 v[184:187], a[128:131], a[36:39], v[184:187]
    v_exp_f32 v171, v171
    v_mfma_f32_16x16x32_bf16 v[184:187], a[132:135], a[40:43], v[184:187]
    v_cvt_pk_bf16_f32 v154, v168, v169
    v_cvt_pk_bf16_f32 v155, v170, v171
    v_mfma_f32_16x16x32_bf16 v[184:187], a[136:139], a[44:47], v[184:187]
    global_load_dwordx4 a[104:107], v245, s[62:63] offset:0 sc1
    v_mfma_f32_16x16x32_bf16 v[188:191], a[136:139], a[60:63], 0
    s_load_dword s12, s[0:1], 4
    v_exp_f32 v176, v176
    v_mfma_f32_16x16x32_bf16 v[188:191], a[132:135], a[56:59], v[188:191]
    s_load_dword s13, s[0:1], 2052
    v_exp_f32 v177, v177
    v_mfma_f32_16x16x32_bf16 v[188:191], a[128:131], a[52:55], v[188:191]
    s_load_dword s14, s[0:1], 4100
    v_exp_f32 v178, v178
    v_mfma_f32_16x16x32_bf16 v[188:191], a[124:127], a[48:51], v[188:191]
    s_waitcnt vmcnt(13)
    global_load_dwordx4 a[100:103], v245, s[62:63] offset:1024 sc1
    v_cvt_pk_bf16_f32 v176, v176, v177
    v_mfma_f32_16x16x32_bf16 v[192:195], a[140:143], a[0:3], 0
    s_load_dword s15, s[0:1], 6148
    v_exp_f32 v179, v179
    v_mfma_f32_16x16x32_bf16 v[192:195], a[144:147], a[4:7], v[192:195]
    s_load_dword s16, s[0:1], 8196
    v_exp_f32 v180, v180
    v_mfma_f32_16x16x32_bf16 v[192:195], a[148:151], a[8:11], v[192:195]
    s_load_dword s17, s[0:1], 10244
    v_exp_f32 v181, v181
    v_mfma_f32_16x16x32_bf16 v[192:195], a[152:155], a[12:15], v[192:195]
    global_load_dwordx4 a[96:99], v245, s[62:63] offset:2048 sc1
    v_cvt_pk_bf16_f32 v177, v178, v179
    v_mfma_f32_16x16x32_bf16 v[196:199], a[152:155], a[28:31], 0
    s_load_dword s22, s[0:1], 12292
    v_exp_f32 v182, v182
    v_mfma_f32_16x16x32_bf16 v[196:199], a[148:151], a[24:27], v[196:199]
    s_load_dword s23, s[0:1], 14340
    v_exp_f32 v183, v183
    v_mfma_f32_16x16x32_bf16 v[196:199], a[144:147], a[20:23], v[196:199]
    s_load_dword s36, s[10:11], 0
    v_cvt_pk_bf16_f32 v180, v180, v181
    v_cvt_pk_bf16_f32 v181, v182, v183
    v_mfma_f32_16x16x32_bf16 v[196:199], a[140:143], a[16:19], v[196:199]
    global_load_dwordx4 a[92:95], v245, s[62:63] offset:3072 sc1
    v_mfma_f32_16x16x32_bf16 v[200:203], a[140:143], a[32:35], 0
    v_exp_f32 v192, v192
    v_mfma_f32_16x16x32_bf16 v[200:203], a[144:147], a[36:39], v[200:203]
    v_exp_f32 v193, v193
    v_mfma_f32_16x16x32_bf16 v[200:203], a[148:151], a[40:43], v[200:203]
    v_exp_f32 v194, v194
    v_mfma_f32_16x16x32_bf16 v[200:203], a[152:155], a[44:47], v[200:203]
    global_load_dwordx4 a[120:123], v244, s[64:65] offset:0 sc1
    v_cvt_pk_bf16_f32 v178, v192, v193
    v_mfma_f32_16x16x32_bf16 v[204:207], a[152:155], a[60:63], 0
    v_exp_f32 v195, v195
    v_mfma_f32_16x16x32_bf16 v[204:207], a[148:151], a[56:59], v[204:207]
    v_exp_f32 v196, v196
    v_mfma_f32_16x16x32_bf16 v[204:207], a[144:147], a[52:55], v[204:207]
    v_exp_f32 v197, v197
    v_mfma_f32_16x16x32_bf16 v[204:207], a[140:143], a[48:51], v[204:207]
    s_waitcnt vmcnt(13)
    global_load_dwordx4 a[116:119], v244, s[64:65] offset:1024 sc1
    v_cvt_pk_bf16_f32 v179, v194, v195
    v_mfma_f32_16x16x32_bf16 v[208:211], a[156:159], a[0:3], 0
    v_exp_f32 v198, v198
    v_mfma_f32_16x16x32_bf16 v[208:211], a[160:163], a[4:7], v[208:211]
    v_exp_f32 v199, v199
    v_mfma_f32_16x16x32_bf16 v[208:211], a[164:167], a[8:11], v[208:211]
    v_cvt_pk_bf16_f32 v182, v196, v197
    v_cvt_pk_bf16_f32 v183, v198, v199
    v_mfma_f32_16x16x32_bf16 v[208:211], a[168:171], a[12:15], v[208:211]
    global_load_dwordx4 a[112:115], v244, s[64:65] offset:2048 sc1
    v_mfma_f32_16x16x32_bf16 v[212:215], a[168:171], a[28:31], 0
    v_exp_f32 v156, v156
    v_mfma_f32_16x16x32_bf16 v[212:215], a[164:167], a[24:27], v[212:215]
    v_exp_f32 v157, v157
    v_mfma_f32_16x16x32_bf16 v[212:215], a[160:163], a[20:23], v[212:215]
    v_exp_f32 v158, v158
    v_mfma_f32_16x16x32_bf16 v[212:215], a[156:159], a[16:19], v[212:215]
    global_load_dwordx4 a[108:111], v244, s[64:65] offset:3072 sc1
    v_cvt_pk_bf16_f32 v156, v156, v157
    v_mfma_f32_16x16x32_bf16 v[216:219], a[156:159], a[32:35], 0
    s_waitcnt lgkmcnt(0)
    s_cmp_lg_u64 s[12:13], s[24:25]
    s_cbranch_scc1 L_spin
    s_cmp_lg_u64 s[14:15], s[24:25]
    s_cbranch_scc1 L_spin
    s_cmp_lg_u64 s[16:17], s[24:25]
    s_cbranch_scc1 L_spin
    s_cmp_lg_u64 s[22:23], s[24:25]
    s_cbranch_scc1 L_spin
L_spinback:
    v_mfma_f32_16x16x32_bf16 v[216:219], a[160:163], a[36:39], v[216:219]
    v_exp_f32 v159, v159
    v_mfma_f32_16x16x32_bf16 v[216:219], a[164:167], a[40:43], v[216:219]
    v_exp_f32 v172, v172
    v_mfma_f32_16x16x32_bf16 v[216:219], a[168:171], a[44:47], v[216:219]
    global_load_dwordx4 a[136:139], v246, s[56:57] offset:0 sc1
    v_cvt_pk_bf16_f32 v157, v158, v159
    v_mfma_f32_16x16x32_bf16 v[220:223], a[168:171], a[60:63], 0
    v_exp_f32 v173, v173
    v_mfma_f32_16x16x32_bf16 v[220:223], a[164:167], a[56:59], v[220:223]
    v_exp_f32 v174, v174
    v_mfma_f32_16x16x32_bf16 v[220:223], a[160:163], a[52:55], v[220:223]
    v_exp_f32 v175, v175
    v_mfma_f32_16x16x32_bf16 v[220:223], a[156:159], a[48:51], v[220:223]
    s_waitcnt vmcnt(13)
    global_load_dwordx4 a[132:135], v246, s[58:59] offset:0 sc1
    v_cvt_pk_bf16_f32 v158, v172, v173
    v_mfma_f32_16x16x32_bf16 v[232:235], a[172:175], a[0:3], 0
    v_exp_f32 v184, v184
    v_mfma_f32_16x16x32_bf16 v[232:235], a[176:179], a[4:7], v[232:235]
    v_exp_f32 v185, v185
    v_mfma_f32_16x16x32_bf16 v[232:235], a[180:183], a[8:11], v[232:235]
    v_cvt_pk_bf16_f32 v184, v184, v185
    v_cvt_pk_bf16_f32 v159, v174, v175
    v_mfma_f32_16x16x32_bf16 v[232:235], a[184:187], a[12:15], v[232:235]
    global_load_dwordx4 a[128:131], v246, s[56:57] offset:1024 sc1
    v_mfma_f32_16x16x32_bf16 v[236:239], a[184:187], a[28:31], 0
    v_exp_f32 v186, v186
    v_mfma_f32_16x16x32_bf16 v[236:239], a[180:183], a[24:27], v[236:239]
    v_exp_f32 v187, v187
    v_mfma_f32_16x16x32_bf16 v[236:239], a[176:179], a[20:23], v[236:239]
    v_exp_f32 v200, v200
    v_mfma_f32_16x16x32_bf16 v[236:239], a[172:175], a[16:19], v[236:239]
    global_load_dwordx4 a[124:127], v246, s[58:59] offset:1024 sc1
    v_cvt_pk_bf16_f32 v185, v186, v187
    v_mfma_f32_16x16x32_bf16 v[224:227], a[172:175], a[32:35], 0
    v_exp_f32 v201, v201
    v_mfma_f32_16x16x32_bf16 v[224:227], a[176:179], a[36:39], v[224:227]
    v_exp_f32 v202, v202
    v_mfma_f32_16x16x32_bf16 v[224:227], a[180:183], a[40:43], v[224:227]
    v_exp_f32 v203, v203
    v_mfma_f32_16x16x32_bf16 v[224:227], a[184:187], a[44:47], v[224:227]
    global_load_dwordx4 a[152:155], v246, s[56:57] offset:2048 sc1
    v_cvt_pk_bf16_f32 v186, v200, v201
    v_mfma_f32_16x16x32_bf16 v[228:231], a[184:187], a[60:63], 0
    v_exp_f32 v188, v188
    v_mfma_f32_16x16x32_bf16 v[228:231], a[180:183], a[56:59], v[228:231]
    v_exp_f32 v189, v189
    v_mfma_f32_16x16x32_bf16 v[228:231], a[176:179], a[52:55], v[228:231]
    v_cvt_pk_bf16_f32 v187, v202, v203
    v_cvt_pk_bf16_f32 v188, v188, v189
    v_mfma_f32_16x16x32_bf16 v[228:231], a[172:175], a[48:51], v[228:231]
    s_waitcnt vmcnt(13)
    global_load_dwordx4 a[148:151], v246, s[58:59] offset:2048 sc1
    v_mfma_f32_16x16x32_bf16 v[160:163], a[188:191], a[0:3], 0
    v_exp_f32 v190, v190
    v_mfma_f32_16x16x32_bf16 v[160:163], a[192:195], a[4:7], v[160:163]
    v_exp_f32 v191, v191
    v_mfma_f32_16x16x32_bf16 v[160:163], a[196:199], a[8:11], v[160:163]
    v_exp_f32 v204, v204
    v_mfma_f32_16x16x32_bf16 v[160:163], a[200:203], a[12:15], v[160:163]
    global_load_dwordx4 a[144:147], v246, s[56:57] offset:3072 sc1
    v_cvt_pk_bf16_f32 v189, v190, v191
    v_mfma_f32_16x16x32_bf16 v[164:167], a[200:203], a[28:31], 0
    v_exp_f32 v205, v205
    v_mfma_f32_16x16x32_bf16 v[164:167], a[196:199], a[24:27], v[164:167]
    v_exp_f32 v206, v206
    v_mfma_f32_16x16x32_bf16 v[164:167], a[192:195], a[20:23], v[164:167]
    v_exp_f32 v207, v207
    v_mfma_f32_16x16x32_bf16 v[164:167], a[188:191], a[16:19], v[164:167]
    global_load_dwordx4 a[140:143], v246, s[58:59] offset:3072 sc1
    v_cvt_pk_bf16_f32 v190, v204, v205
    v_mfma_f32_16x16x32_bf16 v[168:171], a[188:191], a[32:35], 0
    v_exp_f32 v208, v208
    v_mfma_f32_16x16x32_bf16 v[168:171], a[192:195], a[36:39], v[168:171]
    v_exp_f32 v209, v209
    v_mfma_f32_16x16x32_bf16 v[168:171], a[196:199], a[40:43], v[168:171]
    v_cvt_pk_bf16_f32 v191, v206, v207
    v_cvt_pk_bf16_f32 v208, v208, v209
    v_mfma_f32_16x16x32_bf16 v[168:171], a[200:203], a[44:47], v[168:171]
    global_load_dwordx4 a[168:171], v247, s[56:57] offset:0 sc1
    v_mfma_f32_16x16x32_bf16 v[192:195], a[200:203], a[60:63], 0
    v_exp_f32 v210, v210
    v_mfma_f32_16x16x32_bf16 v[192:195], a[196:199], a[56:59], v[192:195]
    v_exp_f32 v211, v211
    v_mfma_f32_16x16x32_bf16 v[192:195], a[192:195], a[52:55], v[192:195]
    v_exp_f32 v232, v232
    v_mfma_f32_16x16x32_bf16 v[192:195], a[188:191], a[48:51], v[192:195]
    s_waitcnt vmcnt(13)
    global_load_dwordx4 a[164:167], v247, s[58:59] offset:0 sc1
    v_cvt_pk_bf16_f32 v209, v210, v211
    v_mfma_f32_16x16x32_bf16 v[196:199], a[104:107], a[0:3], 0
    v_exp_f32 v233, v233
    v_mfma_f32_16x16x32_bf16 v[196:199], a[100:103], a[4:7], v[196:199]
    v_exp_f32 v234, v234
    v_mfma_f32_16x16x32_bf16 v[196:199], a[96:99], a[8:11], v[196:199]
    v_exp_f32 v235, v235
    v_mfma_f32_16x16x32_bf16 v[196:199], a[92:95], a[12:15], v[196:199]
    global_load_dwordx4 a[160:163], v247, s[56:57] offset:1024 sc1
    v_cvt_pk_bf16_f32 v210, v232, v233
    v_mfma_f32_16x16x32_bf16 v[172:175], a[92:95], a[28:31], 0
    v_exp_f32 v212, v212
    v_mfma_f32_16x16x32_bf16 v[172:175], a[96:99], a[24:27], v[172:175]
    v_exp_f32 v213, v213
    v_mfma_f32_16x16x32_bf16 v[172:175], a[100:103], a[20:23], v[172:175]
    v_cvt_pk_bf16_f32 v211, v234, v235
    v_cvt_pk_bf16_f32 v212, v212, v213
    v_mfma_f32_16x16x32_bf16 v[172:175], a[104:107], a[16:19], v[172:175]
    global_load_dwordx4 a[156:159], v247, s[58:59] offset:1024 sc1
    v_mfma_f32_16x16x32_bf16 v[200:203], a[104:107], a[32:35], 0
    v_exp_f32 v214, v214
    v_mfma_f32_16x16x32_bf16 v[200:203], a[100:103], a[36:39], v[200:203]
    v_exp_f32 v215, v215
    v_mfma_f32_16x16x32_bf16 v[200:203], a[96:99], a[40:43], v[200:203]
    v_exp_f32 v236, v236
    v_mfma_f32_16x16x32_bf16 v[200:203], a[92:95], a[44:47], v[200:203]
    global_load_dwordx4 a[184:187], v247, s[56:57] offset:2048 sc1
    v_cvt_pk_bf16_f32 v213, v214, v215
    v_mfma_f32_16x16x32_bf16 v[204:207], a[92:95], a[60:63], 0
    v_exp_f32 v237, v237
    v_mfma_f32_16x16x32_bf16 v[204:207], a[96:99], a[56:59], v[204:207]
    v_exp_f32 v238, v238
    v_mfma_f32_16x16x32_bf16 v[204:207], a[100:103], a[52:55], v[204:207]
    v_exp_f32 v239, v239
    v_mfma_f32_16x16x32_bf16 v[204:207], a[104:107], a[48:51], v[204:207]
    s_waitcnt vmcnt(11)
    s_barrier
    global_load_dwordx4 a[180:183], v247, s[58:59] offset:2048 sc1
    v_cvt_pk_bf16_f32 v214, v236, v237
    v_mfma_f32_16x16x32_bf16 v[16:19], v[144:147], a[136:139], 0
    v_exp_f32 v216, v216
    v_mfma_f32_16x16x32_bf16 v[16:19], v[176:179], a[132:135], v[16:19]
    global_load_dwordx4 a[176:179], v247, s[56:57] offset:3072 sc1
    v_cvt_pk_bf16_f32 v215, v238, v239
    v_mfma_f32_16x16x32_bf16 v[20:23], v[180:183], a[132:135], 0
    v_exp_f32 v217, v217
    v_mfma_f32_16x16x32_bf16 v[20:23], v[148:151], a[136:139], v[20:23]
    v_exp_f32 v218, v218
    v_mfma_f32_16x16x32_bf16 v[24:27], v[152:155], a[136:139], 0
    v_exp_f32 v219, v219
    v_mfma_f32_16x16x32_bf16 v[24:27], v[184:187], a[132:135], v[24:27]
    global_load_dwordx4 a[172:175], v247, s[58:59] offset:3072 sc1
    v_cvt_pk_bf16_f32 v216, v216, v217
    v_mfma_f32_16x16x32_bf16 v[28:31], v[188:191], a[132:135], 0
    v_exp_f32 v224, v224
    v_mfma_f32_16x16x32_bf16 v[28:31], v[156:159], a[136:139], v[28:31]
    v_exp_f32 v225, v225
    v_mfma_f32_16x16x32_bf16 v[240:243], a[76:79], v[176:179], 0
    v_cvt_pk_bf16_f32 v217, v218, v219
    v_cvt_pk_bf16_f32 v218, v224, v225
    v_mfma_f32_16x16x32_bf16 v[240:243], a[80:83], v[180:183], v[240:243]
    v_exp_f32 v226, v226
    v_mfma_f32_16x16x32_bf16 v[240:243], a[84:87], v[184:187], v[240:243]
    v_exp_f32 v227, v227
    v_mfma_f32_16x16x32_bf16 v[240:243], a[88:91], v[188:191], v[240:243]
    v_exp_f32 v160, v160
    v_mfma_f32_16x16x32_bf16 v[240:243], a[76:79], v[144:147], v[240:243]
    v_exp_f32 v161, v161
    v_mfma_f32_16x16x32_bf16 v[240:243], a[80:83], v[148:151], v[240:243]
    v_cvt_pk_bf16_f32 v160, v160, v161
    v_cvt_pk_bf16_f32 v219, v226, v227
    v_mfma_f32_16x16x32_bf16 v[240:243], a[84:87], v[152:155], v[240:243]
    v_exp_f32 v162, v162
    v_mfma_f32_16x16x32_bf16 v[240:243], a[88:91], v[156:159], v[240:243]
    s_waitcnt vmcnt(12)
    global_load_dwordx4 a[200:203], v245, s[64:65] offset:0 sc1
    v_mfma_f32_16x16x32_bf16 v[32:35], v[144:147], a[128:131], 0
    v_exp_f32 v163, v163
    v_mfma_f32_16x16x32_bf16 v[32:35], v[176:179], a[124:127], v[32:35]
    global_load_dwordx4 a[196:199], v245, s[64:65] offset:1024 sc1
    v_cvt_pk_bf16_f32 v161, v162, v163
    v_mfma_f32_16x16x32_bf16 v[36:39], v[180:183], a[124:127], 0
    v_exp_f32 v196, v196
    v_mfma_f32_16x16x32_bf16 v[36:39], v[148:151], a[128:131], v[36:39]
    v_exp_f32 v197, v197
    v_mfma_f32_16x16x32_bf16 v[40:43], v[152:155], a[128:131], 0
    v_exp_f32 v198, v198
    v_mfma_f32_16x16x32_bf16 v[40:43], v[184:187], a[124:127], v[40:43]
    global_load_dwordx4 a[192:195], v245, s[64:65] offset:2048 sc1
    v_cvt_pk_bf16_f32 v162, v196, v197
    v_mfma_f32_16x16x32_bf16 v[44:47], v[188:191], a[124:127], 0
    v_exp_f32 v199, v199
    v_mfma_f32_16x16x32_bf16 v[44:47], v[156:159], a[128:131], v[44:47]
    s_waitcnt vmcnt(13)
    v_exp_f32 v164, v164
    v_mfma_f32_16x16x32_bf16 v[48:51], v[144:147], a[152:155], 0
    v_exp_f32 v165, v165
    v_mfma_f32_16x16x32_bf16 v[48:51], v[176:179], a[148:151], v[48:51]
    global_load_dwordx4 a[188:191], v245, s[64:65] offset:3072 sc1
    v_cvt_pk_bf16_f32 v163, v198, v199
    v_mfma_f32_16x16x32_bf16 v[52:55], v[180:183], a[148:151], 0
    v_exp_f32 v166, v166
    v_mfma_f32_16x16x32_bf16 v[52:55], v[148:151], a[152:155], v[52:55]
    v_exp_f32 v167, v167
    v_mfma_f32_16x16x32_bf16 v[56:59], v[152:155], a[152:155], 0
    v_cvt_pk_bf16_f32 v164, v164, v165
    v_cvt_pk_bf16_f32 v165, v166, v167
    v_mfma_f32_16x16x32_bf16 v[56:59], v[184:187], a[148:151], v[56:59]
    global_load_dwordx4 a[92:95], v244, s[66:67] offset:0 sc1
    v_mfma_f32_16x16x32_bf16 v[60:63], v[188:191], a[148:151], 0
    v_exp_f32 v172, v172
    v_mfma_f32_16x16x32_bf16 v[60:63], v[156:159], a[152:155], v[60:63]
    s_waitcnt vmcnt(13)
    v_exp_f32 v173, v173
    v_mfma_f32_16x16x32_bf16 v[64:67], v[144:147], a[144:147], 0
    v_exp_f32 v174, v174
    v_mfma_f32_16x16x32_bf16 v[64:67], v[176:179], a[140:143], v[64:67]
    global_load_dwordx4 a[96:99], v244, s[66:67] offset:1024 sc1
    v_cvt_pk_bf16_f32 v166, v172, v173
    v_mfma_f32_16x16x32_bf16 v[68:71], v[180:183], a[140:143], 0
    v_exp_f32 v175, v175
    v_mfma_f32_16x16x32_bf16 v[68:71], v[148:151], a[144:147], v[68:71]
    v_exp_f32 v220, v220
    v_mfma_f32_16x16x32_bf16 v[72:75], v[152:155], a[144:147], 0
    v_exp_f32 v221, v221
    v_mfma_f32_16x16x32_bf16 v[72:75], v[184:187], a[140:143], v[72:75]
    global_load_dwordx4 a[100:103], v244, s[66:67] offset:2048 sc1
    v_cvt_pk_bf16_f32 v167, v174, v175
    v_mfma_f32_16x16x32_bf16 v[76:79], v[188:191], a[140:143], 0
    v_exp_f32 v222, v222
    v_mfma_f32_16x16x32_bf16 v[76:79], v[156:159], a[144:147], v[76:79]
    s_waitcnt vmcnt(13)
    v_exp_f32 v223, v223
    v_mfma_f32_16x16x32_bf16 v[80:83], v[144:147], a[168:171], 0
    v_cvt_pk_bf16_f32 v220, v220, v221
    v_cvt_pk_bf16_f32 v221, v222, v223
    v_mfma_f32_16x16x32_bf16 v[80:83], v[176:179], a[164:167], v[80:83]
    global_load_dwordx4 a[104:107], v244, s[66:67] offset:3072 sc1
    v_mfma_f32_16x16x32_bf16 v[84:87], v[180:183], a[164:167], 0
L_hook1:
    s_cbranch_execz L_hook2
    v_exp_f32 v228, v228
    v_mfma_f32_16x16x32_bf16 v[84:87], v[148:151], a[168:171], v[84:87]
    v_exp_f32 v229, v229
    v_mfma_f32_16x16x32_bf16 v[88:91], v[152:155], a[168:171], 0
    v_exp_f32 v230, v230
    v_mfma_f32_16x16x32_bf16 v[88:91], v[184:187], a[164:167], v[88:91]
    global_load_dwordx4 a[132:135], v245, s[66:67] offset:0 sc1
    v_cvt_pk_bf16_f32 v222, v228, v229
    v_mfma_f32_16x16x32_bf16 v[92:95], v[188:191], a[164:167], 0
    v_exp_f32 v231, v231
    v_mfma_f32_16x16x32_bf16 v[92:95], v[156:159], a[168:171], v[92:95]
    s_waitcnt vmcnt(13)
    v_exp_f32 v168, v168
    v_mfma_f32_16x16x32_bf16 v[96:99], v[144:147], a[160:163], 0
    v_exp_f32 v169, v169
    v_mfma_f32_16x16x32_bf16 v[96:99], v[176:179], a[156:159], v[96:99]
    global_load_dwordx4 a[136:139], v245, s[66:67] offset:1024 sc1
    v_cvt_pk_bf16_f32 v168, v168, v169
    v_mfma_f32_16x16x32_bf16 v[100:103], v[180:183], a[156:159], 0
    v_exp_f32 v170, v170
    v_mfma_f32_16x16x32_bf16 v[100:103], v[148:151], a[160:163], v[100:103]
    v_exp_f32 v171, v171
    v_mfma_f32_16x16x32_bf16 v[104:107], v[152:155], a[160:163], 0
    v_cvt_pk_bf16_f32 v169, v170, v171
    v_cvt_pk_bf16_f32 v223, v230, v231
    v_mfma_f32_16x16x32_bf16 v[104:107], v[184:187], a[156:159], v[104:107]
    global_load_dwordx4 a[124:127], v245, s[66:67] offset:2048 sc1
    v_mfma_f32_16x16x32_bf16 v[108:111], v[188:191], a[156:159], 0
    v_exp_f32 v200, v200
    v_mfma_f32_16x16x32_bf16 v[108:111], v[156:159], a[160:163], v[108:111]
    s_waitcnt vmcnt(13)
    v_exp_f32 v201, v201
    v_mfma_f32_16x16x32_bf16 v[112:115], v[144:147], a[184:187], 0
    v_exp_f32 v202, v202
    v_mfma_f32_16x16x32_bf16 v[112:115], v[176:179], a[180:183], v[112:115]
    global_load_dwordx4 a[128:131], v245, s[66:67] offset:3072 sc1
    v_cvt_pk_bf16_f32 v170, v200, v201
    v_mfma_f32_16x16x32_bf16 v[116:119], v[180:183], a[180:183], 0
    v_exp_f32 v203, v203
    v_mfma_f32_16x16x32_bf16 v[116:119], v[148:151], a[184:187], v[116:119]
    v_exp_f32 v192, v192
    v_mfma_f32_16x16x32_bf16 v[120:123], v[152:155], a[184:187], 0
    v_exp_f32 v193, v193
    v_mfma_f32_16x16x32_bf16 v[120:123], v[184:187], a[180:183], v[120:123]
    global_load_dwordx4 a[148:151], v246, s[60:61] offset:0 sc1
    v_cvt_pk_bf16_f32 v171, v202, v203
    v_mfma_f32_16x16x32_bf16 v[124:127], v[188:191], a[180:183], 0
    v_exp_f32 v194, v194
    v_mfma_f32_16x16x32_bf16 v[124:127], v[156:159], a[184:187], v[124:127]
    s_waitcnt vmcnt(13)
    v_exp_f32 v195, v195
    v_mfma_f32_16x16x32_bf16 v[128:131], v[144:147], a[176:179], 0
    v_cvt_pk_bf16_f32 v192, v192, v193
    v_cvt_pk_bf16_f32 v193, v194, v195
    v_mfma_f32_16x16x32_bf16 v[128:131], v[176:179], a[172:175], v[128:131]
    global_load_dwordx4 a[152:155], v246, s[62:63] offset:0 sc1
    v_mfma_f32_16x16x32_bf16 v[132:135], v[180:183], a[172:175], 0
    v_exp_f32 v204, v204
    v_mfma_f32_16x16x32_bf16 v[132:135], v[148:151], a[176:179], v[132:135]
    v_exp_f32 v205, v205
    v_mfma_f32_16x16x32_bf16 v[136:139], v[152:155], a[176:179], 0
    v_exp_f32 v206, v206
    v_mfma_f32_16x16x32_bf16 v[136:139], v[184:187], a[172:175], v[136:139]
    global_load_dwordx4 a[140:143], v246, s[60:61] offset:1024 sc1
    v_cvt_pk_bf16_f32 v194, v204, v205
    v_mfma_f32_16x16x32_bf16 v[140:143], v[188:191], a[172:175], 0
    v_exp_f32 v207, v207
    v_mfma_f32_16x16x32_bf16 v[140:143], v[156:159], a[176:179], v[140:143]
    v_cvt_pk_bf16_f32 v195, v206, v207
    v_mfma_f32_16x16x32_bf16 v[232:235], a[120:123], a[0:3], 0
    v_mfma_f32_16x16x32_bf16 v[232:235], a[116:119], a[4:7], v[232:235]
    v_mfma_f32_16x16x32_bf16 v[232:235], a[112:115], a[8:11], v[232:235]
    v_mfma_f32_16x16x32_bf16 v[232:235], a[108:111], a[12:15], v[232:235]
    global_load_dwordx4 a[144:147], v246, s[62:63] offset:1024 sc1
    v_mfma_f32_16x16x32_bf16 v[236:239], a[108:111], a[28:31], 0
    v_mfma_f32_16x16x32_bf16 v[236:239], a[112:115], a[24:27], v[236:239]
    v_mfma_f32_16x16x32_bf16 v[236:239], a[116:119], a[20:23], v[236:239]
    v_mfma_f32_16x16x32_bf16 v[236:239], a[120:123], a[16:19], v[236:239]
    global_load_dwordx4 a[164:167], v246, s[60:61] offset:2048 sc1
    v_mfma_f32_16x16x32_bf16 v[224:227], a[120:123], a[32:35], 0
    s_nop 0
    v_exp_f32 v232, v232
    v_mfma_f32_16x16x32_bf16 v[224:227], a[116:119], a[36:39], v[224:227]
    v_exp_f32 v233, v233
    v_mfma_f32_16x16x32_bf16 v[224:227], a[112:115], a[40:43], v[224:227]
    v_exp_f32 v234, v234
    v_mfma_f32_16x16x32_bf16 v[224:227], a[108:111], a[44:47], v[224:227]
    global_load_dwordx4 a[168:171], v246, s[62:63] offset:2048 sc1
    v_cvt_pk_bf16_f32 v232, v232, v233
    v_mfma_f32_16x16x32_bf16 v[196:199], a[108:111], a[60:63], 0
    v_exp_f32 v235, v235
    v_mfma_f32_16x16x32_bf16 v[196:199], a[112:115], a[56:59], v[196:199]
    v_exp_f32 v236, v236
    v_mfma_f32_16x16x32_bf16 v[196:199], a[116:119], a[52:55], v[196:199]
    v_exp_f32 v237, v237
    v_mfma_f32_16x16x32_bf16 v[196:199], a[120:123], a[48:51], v[196:199]
    s_waitcnt vmcnt(14)
    global_load_dwordx4 a[156:159], v246, s[60:61] offset:3072 sc1
    v_cvt_pk_bf16_f32 v233, v234, v235
    v_mfma_f32_16x16x32_bf16 v[172:175], a[200:203], a[0:3], 0
    v_exp_f32 v238, v238
    v_mfma_f32_16x16x32_bf16 v[172:175], a[196:199], a[4:7], v[172:175]
    v_exp_f32 v239, v239
    v_mfma_f32_16x16x32_bf16 v[172:175], a[192:195], a[8:11], v[172:175]
    v_cvt_pk_bf16_f32 v236, v236, v237
    v_cvt_pk_bf16_f32 v237, v238, v239
    v_mfma_f32_16x16x32_bf16 v[172:175], a[188:191], a[12:15], v[172:175]
    global_load_dwordx4 a[160:163], v246, s[62:63] offset:3072 sc1
    v_mfma_f32_16x16x32_bf16 v[228:231], a[188:191], a[28:31], 0
    v_exp_f32 v224, v224
    v_mfma_f32_16x16x32_bf16 v[228:231], a[192:195], a[24:27], v[228:231]
    v_exp_f32 v225, v225
    v_mfma_f32_16x16x32_bf16 v[228:231], a[196:199], a[20:23], v[228:231]
    v_exp_f32 v226, v226
    v_mfma_f32_16x16x32_bf16 v[228:231], a[200:203], a[16:19], v[228:231]
    global_load_dwordx4 a[180:183], v247, s[60:61] offset:0 sc1
    v_cvt_pk_bf16_f32 v224, v224, v225
    v_mfma_f32_16x16x32_bf16 v[200:203], a[200:203], a[32:35], 0
    v_exp_f32 v172, v172
    v_mfma_f32_16x16x32_bf16 v[200:203], a[196:199], a[36:39], v[200:203]
    v_exp_f32 v173, v173
    v_mfma_f32_16x16x32_bf16 v[200:203], a[192:195], a[40:43], v[200:203]
    v_exp_f32 v174, v174
    v_mfma_f32_16x16x32_bf16 v[200:203], a[188:191], a[44:47], v[200:203]
    global_load_dwordx4 a[184:187], v247, s[62:63] offset:0 sc1
    v_cvt_pk_bf16_f32 v234, v172, v173
    v_mfma_f32_16x16x32_bf16 v[144:147], a[188:191], a[60:63], 0
    v_exp_f32 v175, v175
    v_mfma_f32_16x16x32_bf16 v[144:147], a[192:195], a[56:59], v[144:147]
    v_exp_f32 v228, v228
    v_mfma_f32_16x16x32_bf16 v[144:147], a[196:199], a[52:55], v[144:147]
    v_exp_f32 v229, v229
    v_mfma_f32_16x16x32_bf16 v[144:147], a[200:203], a[48:51], v[144:147]
    s_waitcnt vmcnt(14)
    global_load_dwordx4 a[172:175], v247, s[60:61] offset:1024 sc1
    v_cvt_pk_bf16_f32 v235, v174, v175
    v_mfma_f32_16x16x32_bf16 v[176:179], a[92:95], a[0:3], 0
    v_exp_f32 v230, v230
    v_mfma_f32_16x16x32_bf16 v[176:179], a[96:99], a[4:7], v[176:179]
    v_exp_f32 v231, v231
    v_mfma_f32_16x16x32_bf16 v[176:179], a[100:103], a[8:11], v[176:179]
    v_cvt_pk_bf16_f32 v238, v228, v229
    v_cvt_pk_bf16_f32 v239, v230, v231
    v_mfma_f32_16x16x32_bf16 v[176:179], a[104:107], a[12:15], v[176:179]
    global_load_dwordx4 a[176:179], v247, s[62:63] offset:1024 sc1
    v_mfma_f32_16x16x32_bf16 v[180:183], a[104:107], a[28:31], 0
    v_exp_f32 v227, v227
    v_mfma_f32_16x16x32_bf16 v[180:183], a[100:103], a[24:27], v[180:183]
    v_exp_f32 v200, v200
    v_mfma_f32_16x16x32_bf16 v[180:183], a[96:99], a[20:23], v[180:183]
    v_exp_f32 v201, v201
    v_mfma_f32_16x16x32_bf16 v[180:183], a[92:95], a[16:19], v[180:183]
    global_load_dwordx4 a[108:111], v247, s[60:61] offset:2048 sc1
    v_cvt_pk_bf16_f32 v225, v226, v227
    v_mfma_f32_16x16x32_bf16 v[148:151], a[92:95], a[32:35], 0
    v_exp_f32 v202, v202
    v_mfma_f32_16x16x32_bf16 v[148:151], a[96:99], a[36:39], v[148:151]
    v_exp_f32 v203, v203
    v_mfma_f32_16x16x32_bf16 v[148:151], a[100:103], a[40:43], v[148:151]
    v_cvt_pk_bf16_f32 v226, v200, v201
    v_cvt_pk_bf16_f32 v227, v202, v203
    v_mfma_f32_16x16x32_bf16 v[148:151], a[104:107], a[44:47], v[148:151]
    global_load_dwordx4 a[112:115], v247, s[62:63] offset:2048 sc1
    v_mfma_f32_16x16x32_bf16 v[152:155], a[104:107], a[60:63], 0
    v_exp_f32 v176, v176
    v_mfma_f32_16x16x32_bf16 v[152:155], a[100:103], a[56:59], v[152:155]
    v_exp_f32 v177, v177
    v_mfma_f32_16x16x32_bf16 v[152:155], a[96:99], a[52:55], v[152:155]
    v_exp_f32 v178, v178
    v_mfma_f32_16x16x32_bf16 v[152:155], a[92:95], a[48:51], v[152:155]
    s_waitcnt vmcnt(14)
    global_load_dwordx4 a[116:119], v247, s[60:61] offset:3072 sc1
    v_cvt_pk_bf16_f32 v176, v176, v177
    v_mfma_f32_16x16x32_bf16 v[184:187], a[132:135], a[0:3], 0
    v_exp_f32 v179, v179
    v_mfma_f32_16x16x32_bf16 v[184:187], a[136:139], a[4:7], v[184:187]
    v_exp_f32 v180, v180
    v_mfma_f32_16x16x32_bf16 v[184:187], a[124:127], a[8:11], v[184:187]
    v_exp_f32 v181, v181
    v_mfma_f32_16x16x32_bf16 v[184:187], a[128:131], a[12:15], v[184:187]
    global_load_dwordx4 a[120:123], v247, s[62:63] offset:3072 sc1
    v_cvt_pk_bf16_f32 v177, v178, v179
    v_mfma_f32_16x16x32_bf16 v[188:191], a[128:131], a[28:31], 0
    v_exp_f32 v182, v182
    v_mfma_f32_16x16x32_bf16 v[188:191], a[124:127], a[24:27], v[188:191]
    v_exp_f32 v183, v183
    v_mfma_f32_16x16x32_bf16 v[188:191], a[136:139], a[20:23], v[188:191]
    v_cvt_pk_bf16_f32 v180, v180, v181
    v_cvt_pk_bf16_f32 v181, v182, v183
    v_mfma_f32_16x16x32_bf16 v[188:191], a[132:135], a[16:19], v[188:191]
    s_barrier
    global_load_dwordx4 a[188:191], v244, s[68:69] offset:0 sc1
    v_mfma_f32_16x16x32_bf16 v[204:207], a[132:135], a[32:35], 0
    v_exp_f32 v184, v184
    v_mfma_f32_16x16x32_bf16 v[204:207], a[136:139], a[36:39], v[204:207]
    v_exp_f32 v185, v185
    v_mfma_f32_16x16x32_bf16 v[204:207], a[124:127], a[40:43], v[204:207]
    v_exp_f32 v186, v186
    v_mfma_f32_16x16x32_bf16 v[204:207], a[128:131], a[44:47], v[204:207]
    global_load_dwordx4 a[192:195], v244, s[68:69] offset:1024 sc1
    v_cvt_pk_bf16_f32 v178, v184, v185
    v_mfma_f32_16x16x32_bf16 v[156:159], a[128:131], a[60:63], 0
    v_exp_f32 v187, v187
    v_mfma_f32_16x16x32_bf16 v[156:159], a[124:127], a[56:59], v[156:159]
    v_exp_f32 v188, v188
    v_mfma_f32_16x16x32_bf16 v[156:159], a[136:139], a[52:55], v[156:159]
    v_exp_f32 v189, v189
    v_mfma_f32_16x16x32_bf16 v[156:159], a[132:135], a[48:51], v[156:159]
    s_waitcnt vmcnt(16)
    global_load_dwordx4 a[196:199], v244, s[68:69] offset:2048 sc1
    v_cvt_pk_bf16_f32 v179, v186, v187
    v_mfma_f32_16x16x32_bf16 v[16:19], v[208:211], a[148:151], v[16:19]
    v_exp_f32 v190, v190
    v_mfma_f32_16x16x32_bf16 v[16:19], v[160:163], a[152:155], v[16:19]
    global_load_dwordx4 a[200:203], v244, s[68:69] offset:3072 sc1
    v_cvt_pk_bf16_f32 v182, v188, v189
    v_mfma_f32_16x16x32_bf16 v[20:23], v[164:167], a[152:155], v[20:23]
    v_exp_f32 v191, v191
    v_mfma_f32_16x16x32_bf16 v[20:23], v[212:215], a[148:151], v[20:23]
    v_exp_f32 v196, v196
    v_mfma_f32_16x16x32_bf16 v[24:27], v[216:219], a[148:151], v[24:27]
    v_exp_f32 v197, v197
    v_mfma_f32_16x16x32_bf16 v[24:27], v[168:171], a[152:155], v[24:27]
    global_load_dwordx4 a[104:107], v245, s[68:69] offset:0 sc1
    v_cvt_pk_bf16_f32 v183, v190, v191
    v_mfma_f32_16x16x32_bf16 v[28:31], v[192:195], a[152:155], v[28:31]
    v_exp_f32 v198, v198
    v_mfma_f32_16x16x32_bf16 v[28:31], v[220:223], a[148:151], v[28:31]
    v_exp_f32 v199, v199
    v_mfma_f32_16x16x32_bf16 v[240:243], a[76:79], v[160:163], v[240:243]
    v_cvt_pk_bf16_f32 v196, v196, v197
    v_cvt_pk_bf16_f32 v197, v198, v199
    v_mfma_f32_16x16x32_bf16 v[240:243], a[80:83], v[164:167], v[240:243]
    v_exp_f32 v144, v144
    v_mfma_f32_16x16x32_bf16 v[240:243], a[84:87], v[168:171], v[240:243]
    v_exp_f32 v145, v145
    v_mfma_f32_16x16x32_bf16 v[240:243], a[88:91], v[192:195], v[240:243]
    v_exp_f32 v146, v146
    v_mfma_f32_16x16x32_bf16 v[240:243], a[76:79], v[208:211], v[240:243]
    v_exp_f32 v147, v147
    v_mfma_f32_16x16x32_bf16 v[240:243], a[80:83], v[212:215], v[240:243]
    v_cvt_pk_bf16_f32 v198, v144, v145
    v_cvt_pk_bf16_f32 v199, v146, v147
    v_mfma_f32_16x16x32_bf16 v[240:243], a[84:87], v[216:219], v[240:243]
    v_exp_f32 v148, v148
    v_mfma_f32_16x16x32_bf16 v[240:243], a[88:91], v[220:223], v[240:243]
    s_waitcnt vmcnt(17)
    global_load_dwordx4 a[100:103], v245, s[68:69] offset:1024 sc1
    v_mfma_f32_16x16x32_bf16 v[32:35], v[208:211], a[140:143], v[32:35]
    v_exp_f32 v149, v149
    v_mfma_f32_16x16x32_bf16 v[32:35], v[160:163], a[144:147], v[32:35]
    global_load_dwordx4 a[96:99], v245, s[68:69] offset:2048 sc1
    v_cvt_pk_bf16_f32 v148, v148, v149
    v_mfma_f32_16x16x32_bf16 v[36:39], v[164:167], a[144:147], v[36:39]
    v_exp_f32 v150, v150
    v_mfma_f32_16x16x32_bf16 v[36:39], v[212:215], a[140:143], v[36:39]
    v_exp_f32 v151, v151
    v_mfma_f32_16x16x32_bf16 v[40:43], v[216:219], a[140:143], v[40:43]
    v_exp_f32 v204, v204
    v_mfma_f32_16x16x32_bf16 v[40:43], v[168:171], a[144:147], v[40:43]
    global_load_dwordx4 a[92:95], v245, s[68:69] offset:3072 sc1
    v_cvt_pk_bf16_f32 v149, v150, v151
    v_mfma_f32_16x16x32_bf16 v[44:47], v[192:195], a[144:147], v[44:47]
    v_exp_f32 v205, v205
    v_mfma_f32_16x16x32_bf16 v[44:47], v[220:223], a[140:143], v[44:47]
    s_waitcnt vmcnt(18)
    v_exp_f32 v206, v206
    v_mfma_f32_16x16x32_bf16 v[48:51], v[208:211], a[164:167], v[48:51]
    v_exp_f32 v207, v207
    v_mfma_f32_16x16x32_bf16 v[48:51], v[160:163], a[168:171], v[48:51]
    global_load_dwordx4 a[128:131], v244, s[70:71] offset:0 sc1
    v_cvt_pk_bf16_f32 v150, v204, v205
    v_mfma_f32_16x16x32_bf16 v[52:55], v[164:167], a[168:171], v[52:55]
    v_exp_f32 v152, v152
    v_mfma_f32_16x16x32_bf16 v[52:55], v[212:215], a[164:167], v[52:55]
    v_exp_f32 v153, v153
    v_mfma_f32_16x16x32_bf16 v[56:59], v[216:219], a[164:167], v[56:59]
    v_cvt_pk_bf16_f32 v151, v206, v207
    v_cvt_pk_bf16_f32 v152, v152, v153
    v_mfma_f32_16x16x32_bf16 v[56:59], v[168:171], a[168:171], v[56:59]
    global_load_dwordx4 a[124:127], v244, s[70:71] offset:1024 sc1
    v_mfma_f32_16x16x32_bf16 v[60:63], v[192:195], a[168:171], v[60:63]
    v_exp_f32 v154, v154
    v_mfma_f32_16x16x32_bf16 v[60:63], v[220:223], a[164:167], v[60:63]
    s_waitcnt vmcnt(18)
    v_exp_f32 v155, v155
    v_mfma_f32_16x16x32_bf16 v[64:67], v[208:211], a[156:159], v[64:67]
    v_exp_f32 v156, v156
    v_mfma_f32_16x16x32_bf16 v[64:67], v[160:163], a[160:163], v[64:67]
    global_load_dwordx4 a[136:139], v244, s[70:71] offset:2048 sc1
    v_cvt_pk_bf16_f32 v153, v154, v155
    v_mfma_f32_16x16x32_bf16 v[68:71], v[164:167], a[160:163], v[68:71]
    v_exp_f32 v157, v157
    v_mfma_f32_16x16x32_bf16 v[68:71], v[212:215], a[156:159], v[68:71]
    v_exp_f32 v158, v158
    v_mfma_f32_16x16x32_bf16 v[72:75], v[216:219], a[156:159], v[72:75]
    v_exp_f32 v159, v159
    v_mfma_f32_16x16x32_bf16 v[72:75], v[168:171], a[160:163], v[72:75]
    global_load_dwordx4 a[132:135], v244, s[70:71] offset:3072 sc1
    v_cvt_pk_bf16_f32 v154, v156, v157
    v_mfma_f32_16x16x32_bf16 v[76:79], v[192:195], a[160:163], v[76:79]
    v_cvt_pk_bf16_f32 v155, v158, v159
    v_mfma_f32_16x16x32_bf16 v[76:79], v[220:223], a[156:159], v[76:79]
    s_waitcnt vmcnt(18)
    v_mfma_f32_16x16x32_bf16 v[80:83], v[208:211], a[180:183], v[80:83]
    v_mfma_f32_16x16x32_bf16 v[80:83], v[160:163], a[184:187], v[80:83]
    global_load_dwordx4 a[152:155], v245, s[70:71] offset:0 sc1
    v_mfma_f32_16x16x32_bf16 v[84:87], v[164:167], a[184:187], v[84:87]
    v_mfma_f32_16x16x32_bf16 v[84:87], v[212:215], a[180:183], v[84:87]
    v_mfma_f32_16x16x32_bf16 v[88:91], v[216:219], a[180:183], v[88:91]
    v_mfma_f32_16x16x32_bf16 v[88:91], v[168:171], a[184:187], v[88:91]
    global_load_dwordx4 a[148:151], v245, s[70:71] offset:1024 sc1
    v_mfma_f32_16x16x32_bf16 v[92:95], v[192:195], a[184:187], v[92:95]
    v_mfma_f32_16x16x32_bf16 v[92:95], v[220:223], a[180:183], v[92:95]
    s_waitcnt vmcnt(18)
    v_mfma_f32_16x16x32_bf16 v[96:99], v[208:211], a[172:175], v[96:99]
    v_mfma_f32_16x16x32_bf16 v[96:99], v[160:163], a[176:179], v[96:99]
    global_load_dwordx4 a[144:147], v245, s[70:71] offset:2048 sc1
    v_mfma_f32_16x16x32_bf16 v[100:103], v[164:167], a[176:179], v[100:103]
    v_mfma_f32_16x16x32_bf16 v[100:103], v[212:215], a[172:175], v[100:103]
    v_mfma_f32_16x16x32_bf16 v[104:107], v[216:219], a[172:175], v[104:107]
    v_mfma_f32_16x16x32_bf16 v[104:107], v[168:171], a[176:179], v[104:107]
    global_load_dwordx4 a[140:143], v245, s[70:71] offset:3072 sc1
    v_mfma_f32_16x16x32_bf16 v[108:111], v[192:195], a[176:179], v[108:111]
    v_mfma_f32_16x16x32_bf16 v[108:111], v[220:223], a[172:175], v[108:111]
    s_waitcnt vmcnt(18)
    v_mfma_f32_16x16x32_bf16 v[112:115], v[208:211], a[108:111], v[112:115]
    v_mfma_f32_16x16x32_bf16 v[112:115], v[160:163], a[112:115], v[112:115]
    global_load_dwordx4 a[168:171], v246, s[64:65] offset:0 sc1
    v_mfma_f32_16x16x32_bf16 v[116:119], v[164:167], a[112:115], v[116:119]
    v_mfma_f32_16x16x32_bf16 v[116:119], v[212:215], a[108:111], v[116:119]
    v_mfma_f32_16x16x32_bf16 v[120:123], v[216:219], a[108:111], v[120:123]
    v_mfma_f32_16x16x32_bf16 v[120:123], v[168:171], a[112:115], v[120:123]
    global_load_dwordx4 a[164:167], v246, s[66:67] offset:0 sc1
    v_mfma_f32_16x16x32_bf16 v[124:127], v[192:195], a[112:115], v[124:127]
    v_mfma_f32_16x16x32_bf16 v[124:127], v[220:223], a[108:111], v[124:127]
    s_waitcnt vmcnt(18)
    v_mfma_f32_16x16x32_bf16 v[128:131], v[208:211], a[116:119], v[128:131]
    v_mfma_f32_16x16x32_bf16 v[128:131], v[160:163], a[120:123], v[128:131]
    global_load_dwordx4 a[160:163], v246, s[64:65] offset:1024 sc1
    v_mfma_f32_16x16x32_bf16 v[132:135], v[164:167], a[120:123], v[132:135]
    v_mfma_f32_16x16x32_bf16 v[132:135], v[212:215], a[116:119], v[132:135]
    v_mfma_f32_16x16x32_bf16 v[136:139], v[216:219], a[116:119], v[136:139]
    v_mfma_f32_16x16x32_bf16 v[136:139], v[168:171], a[120:123], v[136:139]
    global_load_dwordx4 a[156:159], v246, s[66:67] offset:1024 sc1
    v_mfma_f32_16x16x32_bf16 v[140:143], v[192:195], a[120:123], v[140:143]
    v_mfma_f32_16x16x32_bf16 v[140:143], v[220:223], a[116:119], v[140:143]
    s_waitcnt vmcnt(16)
    v_mfma_f32_16x16x32_bf16 v[172:175], a[188:191], a[0:3], 0
    v_mfma_f32_16x16x32_bf16 v[172:175], a[192:195], a[4:7], v[172:175]
    v_mfma_f32_16x16x32_bf16 v[172:175], a[196:199], a[8:11], v[172:175]
    v_mfma_f32_16x16x32_bf16 v[172:175], a[200:203], a[12:15], v[172:175]
    global_load_dwordx4 a[184:187], v246, s[64:65] offset:2048 sc1
    v_mfma_f32_16x16x32_bf16 v[228:231], a[200:203], a[28:31], 0
    v_mfma_f32_16x16x32_bf16 v[228:231], a[196:199], a[24:27], v[228:231]
    v_mfma_f32_16x16x32_bf16 v[228:231], a[192:195], a[20:23], v[228:231]
    v_mfma_f32_16x16x32_bf16 v[228:231], a[188:191], a[16:19], v[228:231]
    global_load_dwordx4 a[180:183], v246, s[66:67] offset:2048 sc1
    v_mfma_f32_16x16x32_bf16 v[200:203], a[188:191], a[32:35], 0
    s_nop 0
    v_exp_f32 v172, v172
    v_mfma_f32_16x16x32_bf16 v[200:203], a[192:195], a[36:39], v[200:203]
    v_exp_f32 v173, v173
    v_mfma_f32_16x16x32_bf16 v[200:203], a[196:199], a[40:43], v[200:203]
    v_exp_f32 v174, v174
    v_mfma_f32_16x16x32_bf16 v[200:203], a[200:203], a[44:47], v[200:203]
    global_load_dwordx4 a[176:179], v246, s[64:65] offset:3072 sc1
    v_cvt_pk_bf16_f32 v172, v172, v173
    v_mfma_f32_16x16x32_bf16 v[184:187], a[200:203], a[60:63], 0
    v_exp_f32 v228, v228
    v_mfma_f32_16x16x32_bf16 v[184:187], a[196:199], a[56:59], v[184:187]
    v_exp_f32 v229, v229
    v_mfma_f32_16x16x32_bf16 v[184:187], a[192:195], a[52:55], v[184:187]
    v_exp_f32 v230, v230
    v_mfma_f32_16x16x32_bf16 v[184:187], a[188:191], a[48:51], v[184:187]
    s_waitcnt vmcnt(15)
    global_load_dwordx4 a[172:175], v246, s[66:67] offset:3072 sc1
    v_cvt_pk_bf16_f32 v228, v228, v229
    v_mfma_f32_16x16x32_bf16 v[188:191], a[104:107], a[0:3], 0
    v_exp_f32 v231, v231
    v_mfma_f32_16x16x32_bf16 v[188:191], a[100:103], a[4:7], v[188:191]
    v_exp_f32 v175, v175
    v_mfma_f32_16x16x32_bf16 v[188:191], a[96:99], a[8:11], v[188:191]
    v_cvt_pk_bf16_f32 v229, v230, v231
    v_cvt_pk_bf16_f32 v173, v174, v175
    v_mfma_f32_16x16x32_bf16 v[188:191], a[92:95], a[12:15], v[188:191]
    global_load_dwordx4 a[112:115], v247, s[64:65] offset:0 sc1
    v_mfma_f32_16x16x32_bf16 v[144:147], a[92:95], a[28:31], 0
    v_exp_f32 v184, v184
    v_mfma_f32_16x16x32_bf16 v[144:147], a[96:99], a[24:27], v[144:147]
    v_exp_f32 v185, v185
    v_mfma_f32_16x16x32_bf16 v[144:147], a[100:103], a[20:23], v[144:147]
    v_exp_f32 v186, v186
    v_mfma_f32_16x16x32_bf16 v[144:147], a[104:107], a[16:19], v[144:147]
    global_load_dwordx4 a[108:111], v247, s[66:67] offset:0 sc1
    v_cvt_pk_bf16_f32 v184, v184, v185
    v_mfma_f32_16x16x32_bf16 v[204:207], a[104:107], a[32:35], 0
    v_exp_f32 v188, v188
    v_mfma_f32_16x16x32_bf16 v[204:207], a[100:103], a[36:39], v[204:207]
    v_exp_f32 v189, v189
    v_mfma_f32_16x16x32_bf16 v[204:207], a[96:99], a[40:43], v[204:207]
    v_exp_f32 v190, v190
    v_mfma_f32_16x16x32_bf16 v[204:207], a[92:95], a[44:47], v[204:207]
    global_load_dwordx4 a[120:123], v247, s[64:65] offset:1024 sc1
    v_cvt_pk_bf16_f32 v174, v188, v189
    v_mfma_f32_16x16x32_bf16 v[156:159], a[92:95], a[60:63], 0
    v_exp_f32 v144, v144
    v_mfma_f32_16x16x32_bf16 v[156:159], a[96:99], a[56:59], v[156:159]
    v_exp_f32 v145, v145
    v_mfma_f32_16x16x32_bf16 v[156:159], a[100:103], a[52:55], v[156:159]
    v_exp_f32 v146, v146
    v_mfma_f32_16x16x32_bf16 v[156:159], a[104:107], a[48:51], v[156:159]
    s_waitcnt vmcnt(15)
    global_load_dwordx4 a[116:119], v247, s[66:67] offset:1024 sc1
    v_cvt_pk_bf16_f32 v230, v144, v145
    v_mfma_f32_16x16x32_bf16 v[208:211], a[128:131], a[0:3], 0
    v_exp_f32 v147, v147
    v_mfma_f32_16x16x32_bf16 v[208:211], a[124:127], a[4:7], v[208:211]
    v_exp_f32 v191, v191
    v_mfma_f32_16x16x32_bf16 v[208:211], a[136:139], a[8:11], v[208:211]
    v_cvt_pk_bf16_f32 v231, v146, v147
    v_cvt_pk_bf16_f32 v175, v190, v191
    v_mfma_f32_16x16x32_bf16 v[208:211], a[132:135], a[12:15], v[208:211]
    global_load_dwordx4 a[200:203], v247, s[64:65] offset:2048 sc1
    v_mfma_f32_16x16x32_bf16 v[160:163], a[132:135], a[28:31], 0
    v_exp_f32 v187, v187
    v_mfma_f32_16x16x32_bf16 v[160:163], a[136:139], a[24:27], v[160:163]
    v_exp_f32 v156, v156
    v_mfma_f32_16x16x32_bf16 v[160:163], a[124:127], a[20:23], v[160:163]
    v_exp_f32 v157, v157
    v_mfma_f32_16x16x32_bf16 v[160:163], a[128:131], a[16:19], v[160:163]
    global_load_dwordx4 a[196:199], v247, s[66:67] offset:2048 sc1
    v_cvt_pk_bf16_f32 v185, v186, v187
    v_mfma_f32_16x16x32_bf16 v[164:167], a[128:131], a[32:35], 0
    v_exp_f32 v158, v158
    v_mfma_f32_16x16x32_bf16 v[164:167], a[124:127], a[36:39], v[164:167]
    v_exp_f32 v159, v159
    v_mfma_f32_16x16x32_bf16 v[164:167], a[136:139], a[40:43], v[164:167]
    v_cvt_pk_bf16_f32 v186, v156, v157
    v_cvt_pk_bf16_f32 v187, v158, v159
    v_mfma_f32_16x16x32_bf16 v[164:167], a[132:135], a[44:47], v[164:167]
    global_load_dwordx4 a[192:195], v247, s[64:65] offset:3072 sc1
    v_mfma_f32_16x16x32_bf16 v[212:215], a[132:135], a[60:63], 0
    v_exp_f32 v160, v160
    v_mfma_f32_16x16x32_bf16 v[212:215], a[136:139], a[56:59], v[212:215]
    v_exp_f32 v161, v161
    v_mfma_f32_16x16x32_bf16 v[212:215], a[124:127], a[52:55], v[212:215]
    v_exp_f32 v162, v162
    v_mfma_f32_16x16x32_bf16 v[212:215], a[128:131], a[48:51], v[212:215]
    s_waitcnt vmcnt(15)
    s_barrier
    global_load_dwordx4 a[188:191], v247, s[66:67] offset:3072 sc1
    v_cvt_pk_bf16_f32 v160, v160, v161
    v_mfma_f32_16x16x32_bf16 v[216:219], a[152:155], a[0:3], 0
    v_exp_f32 v163, v163
    v_mfma_f32_16x16x32_bf16 v[216:219], a[148:151], a[4:7], v[216:219]
    v_exp_f32 v208, v208
    v_mfma_f32_16x16x32_bf16 v[216:219], a[144:147], a[8:11], v[216:219]
    v_exp_f32 v209, v209
    v_mfma_f32_16x16x32_bf16 v[216:219], a[140:143], a[12:15], v[216:219]
    global_load_dwordx4 a[92:95], v247, s[68:69] offset:0 sc1
    v_cvt_pk_bf16_f32 v161, v162, v163
    v_mfma_f32_16x16x32_bf16 v[168:171], a[140:143], a[28:31], 0
    v_exp_f32 v210, v210
    v_mfma_f32_16x16x32_bf16 v[168:171], a[144:147], a[24:27], v[168:171]
    v_exp_f32 v211, v211
    v_mfma_f32_16x16x32_bf16 v[168:171], a[148:151], a[20:23], v[168:171]
    v_cvt_pk_bf16_f32 v208, v208, v209
    v_cvt_pk_bf16_f32 v209, v210, v211
    v_mfma_f32_16x16x32_bf16 v[168:171], a[152:155], a[16:19], v[168:171]
    global_load_dwordx4 a[96:99], v247, s[70:71] offset:0 sc1
    v_mfma_f32_16x16x32_bf16 v[192:195], a[152:155], a[32:35], 0
    v_exp_f32 v216, v216
    v_mfma_f32_16x16x32_bf16 v[192:195], a[148:151], a[36:39], v[192:195]
    v_exp_f32 v217, v217
    v_mfma_f32_16x16x32_bf16 v[192:195], a[144:147], a[40:43], v[192:195]
    v_exp_f32 v218, v218
    v_mfma_f32_16x16x32_bf16 v[192:195], a[140:143], a[44:47], v[192:195]
    global_load_dwordx4 a[100:103], v247, s[68:69] offset:1024 sc1
    v_cvt_pk_bf16_f32 v210, v216, v217
    v_mfma_f32_16x16x32_bf16 v[220:223], a[140:143], a[60:63], 0
    v_exp_f32 v168, v168
    v_mfma_f32_16x16x32_bf16 v[220:223], a[144:147], a[56:59], v[220:223]
    v_exp_f32 v169, v169
    v_mfma_f32_16x16x32_bf16 v[220:223], a[148:151], a[52:55], v[220:223]
    v_exp_f32 v170, v170
    v_mfma_f32_16x16x32_bf16 v[220:223], a[152:155], a[48:51], v[220:223]
    s_waitcnt vmcnt(17)
    global_load_dwordx4 a[104:107], v247, s[70:71] offset:1024 sc1
    v_cvt_pk_bf16_f32 v162, v168, v169
    v_mfma_f32_16x16x32_bf16 v[16:19], v[232:235], a[168:171], v[16:19]
    v_exp_f32 v171, v171
    v_mfma_f32_16x16x32_bf16 v[16:19], v[176:179], a[164:167], v[16:19]
    global_load_dwordx4 a[132:135], v247, s[68:69] offset:2048 sc1
    v_cvt_pk_bf16_f32 v163, v170, v171
    v_mfma_f32_16x16x32_bf16 v[20:23], v[180:183], a[164:167], v[20:23]
    v_exp_f32 v219, v219
    v_mfma_f32_16x16x32_bf16 v[20:23], v[236:239], a[168:171], v[20:23]
    v_exp_f32 v200, v200
    v_mfma_f32_16x16x32_bf16 v[24:27], v[224:227], a[168:171], v[24:27]
    v_exp_f32 v201, v201
    v_mfma_f32_16x16x32_bf16 v[24:27], v[148:151], a[164:167], v[24:27]
    global_load_dwordx4 a[136:139], v247, s[70:71] offset:2048 sc1
    v_cvt_pk_bf16_f32 v211, v218, v219
    v_mfma_f32_16x16x32_bf16 v[28:31], v[152:155], a[164:167], v[28:31]
    v_exp_f32 v202, v202
    v_mfma_f32_16x16x32_bf16 v[28:31], v[196:199], a[168:171], v[28:31]
    v_exp_f32 v203, v203
    v_mfma_f32_16x16x32_bf16 v[240:243], a[76:79], v[176:179], v[240:243]
    v_cvt_pk_bf16_f32 v200, v200, v201
    v_cvt_pk_bf16_f32 v201, v202, v203
    v_mfma_f32_16x16x32_bf16 v[240:243], a[80:83], v[180:183], v[240:243]
    v_exp_f32 v204, v204
    v_mfma_f32_16x16x32_bf16 v[240:243], a[84:87], v[148:151], v[240:243]
    v_exp_f32 v205, v205
    v_mfma_f32_16x16x32_bf16 v[240:243], a[88:91], v[152:155], v[240:243]
    v_exp_f32 v206, v206
    v_mfma_f32_16x16x32_bf16 v[240:243], a[76:79], v[232:235], v[240:243]
    v_exp_f32 v207, v207
    v_mfma_f32_16x16x32_bf16 v[240:243], a[80:83], v[236:239], v[240:243]
    v_cvt_pk_bf16_f32 v202, v204, v205
    v_cvt_pk_bf16_f32 v203, v206, v207
    v_mfma_f32_16x16x32_bf16 v[240:243], a[84:87], v[224:227], v[240:243]
    v_exp_f32 v212, v212
    v_mfma_f32_16x16x32_bf16 v[240:243], a[88:91], v[196:199], v[240:243]
    s_waitcnt vmcnt(18)
    global_load_dwordx4 a[124:127], v247, s[68:69] offset:3072 sc1
    v_mfma_f32_16x16x32_bf16 v[32:35], v[232:235], a[160:163], v[32:35]
    v_exp_f32 v213, v213
    v_mfma_f32_16x16x32_bf16 v[32:35], v[176:179], a[156:159], v[32:35]
    global_load_dwordx4 a[128:131], v247, s[70:71] offset:3072 sc1
    v_cvt_pk_bf16_f32 v212, v212, v213
    v_mfma_f32_16x16x32_bf16 v[36:39], v[180:183], a[156:159], v[36:39]
    v_exp_f32 v214, v214
    v_mfma_f32_16x16x32_bf16 v[36:39], v[236:239], a[160:163], v[36:39]
    v_exp_f32 v215, v215
    v_mfma_f32_16x16x32_bf16 v[40:43], v[224:227], a[160:163], v[40:43]
    v_exp_f32 v220, v220
    v_mfma_f32_16x16x32_bf16 v[40:43], v[148:151], a[156:159], v[40:43]
    global_load_dwordx4 a[140:143], v246, s[68:69] offset:0 sc1
    v_cvt_pk_bf16_f32 v213, v214, v215
    v_mfma_f32_16x16x32_bf16 v[44:47], v[152:155], a[156:159], v[44:47]
    v_exp_f32 v221, v221
    v_mfma_f32_16x16x32_bf16 v[44:47], v[196:199], a[160:163], v[44:47]
    s_waitcnt vmcnt(19)
    v_exp_f32 v222, v222
    v_mfma_f32_16x16x32_bf16 v[48:51], v[232:235], a[184:187], v[48:51]
    v_exp_f32 v223, v223
    v_mfma_f32_16x16x32_bf16 v[48:51], v[176:179], a[180:183], v[48:51]
    global_load_dwordx4 a[144:147], v246, s[70:71] offset:0 sc1
    v_cvt_pk_bf16_f32 v214, v220, v221
    v_mfma_f32_16x16x32_bf16 v[52:55], v[180:183], a[180:183], v[52:55]
    v_exp_f32 v164, v164
    v_mfma_f32_16x16x32_bf16 v[52:55], v[236:239], a[184:187], v[52:55]
    v_exp_f32 v165, v165
    v_mfma_f32_16x16x32_bf16 v[56:59], v[224:227], a[184:187], v[56:59]
    v_cvt_pk_bf16_f32 v215, v222, v223
    v_cvt_pk_bf16_f32 v164, v164, v165
    v_mfma_f32_16x16x32_bf16 v[56:59], v[148:151], a[180:183], v[56:59]
    global_load_dwordx4 a[148:151], v246, s[70:71] offset:1024 sc1
    v_lshrrev_b32 v1, 4, v0
    v_mfma_f32_16x16x32_bf16 v[60:63], v[152:155], a[180:183], v[60:63]
    v_exp_f32 v166, v166
    v_mfma_f32_16x16x32_bf16 v[60:63], v[196:199], a[184:187], v[60:63]
    s_waitcnt vmcnt(19)
    v_exp_f32 v167, v167
    v_mfma_f32_16x16x32_bf16 v[64:67], v[232:235], a[176:179], v[64:67]
    v_cvt_pk_bf16_f32 v165, v166, v167
    v_bfe_u32 v252, v0, 2, 2
    v_mfma_f32_16x16x32_bf16 v[64:67], v[176:179], a[172:175], v[64:67]
    global_load_dwordx4 a[152:155], v246, s[68:69] offset:1024 sc1
    v_sub_u32 v252, v252, v1
    s_movk_i32 s40, 192
    v_mfma_f32_16x16x32_bf16 v[68:71], v[180:183], a[172:175], v[68:71]
    v_exp_f32 v192, v192
    v_mfma_f32_16x16x32_bf16 v[68:71], v[236:239], a[176:179], v[68:71]
    v_exp_f32 v193, v193
    v_mfma_f32_16x16x32_bf16 v[72:75], v[224:227], a[176:179], v[72:75]
    v_cvt_pk_bf16_f32 v166, v192, v193
    v_mad_i32_i24 v252, v252, s40, v4
    v_mfma_f32_16x16x32_bf16 v[72:75], v[148:151], a[172:175], v[72:75]
    global_load_dwordx4 a[164:167], v246, s[68:69] offset:2048 sc1
    v_lshlrev_b32 v1, 10, v1
    v_mfma_f32_16x16x32_bf16 v[76:79], v[152:155], a[172:175], v[76:79]
    v_exp_f32 v194, v194
    v_mfma_f32_16x16x32_bf16 v[76:79], v[196:199], a[176:179], v[76:79]
    v_exp_f32 v195, v195
    v_mfma_f32_16x16x32_bf16 v[240:243], a[80:83], v[228:231], v[240:243]
    v_cvt_pk_bf16_f32 v167, v194, v195
    v_and_b32 v10, 15, v0
    v_mfma_f32_16x16x32_bf16 v[240:243], a[80:83], v[160:163], v[240:243]
    v_lshl_add_u32 v1, v10, 3, v1
    s_mov_b32 s46, 0x200000
    s_mov_b32 s12, 0x00f000f0
    s_mov_b32 s13, s12
    v_mfma_f32_16x16x32_bf16 v[240:243], a[76:79], v[172:175], v[240:243]
    v_xor_b32 v9, 8192, v4
    v_xor_b32 v10, 24576, v4
    v_mfma_f32_16x16x32_bf16 v[240:243], a[76:79], v[208:211], v[240:243]
    v_mfma_f32_16x16x32_bf16 v[240:243], a[88:91], v[184:187], v[240:243]
    v_mfma_f32_16x16x32_bf16 v[240:243], a[88:91], v[212:215], v[240:243]
    v_mfma_f32_16x16x32_bf16 v[240:243], a[84:87], v[200:203], v[240:243]
L_hook2:
    s_cbranch_execz L_second
    v_mfma_f32_16x16x32_bf16 v[240:243], a[84:87], v[164:167], v[240:243]
    s_waitcnt vmcnt(19)
    global_load_dwordx4 a[168:171], v246, s[70:71] offset:2048 sc1
    v_mfma_f32_16x16x32_bf16 v[80:83], v[232:235], a[112:115], v[80:83]
    v_mfma_f32_16x16x32_bf16 v[80:83], v[176:179], a[108:111], v[80:83]
    global_load_dwordx4 a[156:159], v246, s[70:71] offset:3072 sc1
    v_mfma_f32_16x16x32_bf16 v[84:87], v[180:183], a[108:111], v[84:87]
    v_mfma_f32_16x16x32_bf16 v[84:87], v[236:239], a[112:115], v[84:87]
    v_mfma_f32_16x16x32_bf16 v[88:91], v[224:227], a[112:115], v[88:91]
    v_mfma_f32_16x16x32_bf16 v[88:91], v[148:151], a[108:111], v[88:91]
    global_load_dwordx4 a[160:163], v246, s[68:69] offset:3072 sc1
    v_mfma_f32_16x16x32_bf16 v[92:95], v[152:155], a[108:111], v[92:95]
    ds_write_b128 v252, v[240:243] offset:6144
    s_mov_b32 s41, 0x2b800000
    v_add_f32 v14, v240, v241
    v_min3_f32 v13, v240, v241, v242
    v_mfma_f32_16x16x32_bf16 v[92:95], v[196:199], a[112:115], v[92:95]
    s_waitcnt vmcnt(20)
    v_add_f32 v15, v242, v243
    v_min_f32 v13, v13, v243
    v_mfma_f32_16x16x32_bf16 v[96:99], v[232:235], a[120:123], v[96:99]
    v_add_f32 v14, v14, v15
    v_cmp_nle_f32 s[44:45], s41, v13
    v_mfma_f32_16x16x32_bf16 v[96:99], v[176:179], a[116:119], v[96:99]
    s_barrier
    global_load_dword a207, v8, s[30:31] offset:4 sc1
    v_cmp_nge_f32 vcc, 0x53800000, v14
    v_mfma_f32_16x16x32_bf16 v[100:103], v[180:183], a[116:119], v[100:103]
    v_mov_b32 v14, 26624
    v_mov_b32 v248, 0
    v_mfma_f32_16x16x32_bf16 v[100:103], v[236:239], a[120:123], v[100:103]
    global_load_dword a204, v3, s[26:27] sc1
    v_mov_b32 v250, 0
    v_mfma_f32_16x16x32_bf16 v[104:107], v[224:227], a[120:123], v[104:107]
    s_or_b64 vcc, vcc, s[44:45]
    s_cbranch_scc1 L_setflag
L_flagset:
    v_mfma_f32_16x16x32_bf16 v[104:107], v[148:151], a[116:119], v[104:107]
    global_load_dwordx2 a[204:205], v11, s[30:31] sc1
    s_waitcnt lgkmcnt(0)
    s_barrier
    ds_read_b128 v[144:147], v9 offset:6144
    ds_read_b128 v[188:191], v6 offset:6144
    v_mfma_f32_16x16x32_bf16 v[108:111], v[152:155], a[116:119], v[108:111]
    ds_read_b128 v[156:159], v10 offset:6144
    ds_read_b128 v[168:171], v4 offset:6144
    ds_read_b32 v15, v14
    v_mfma_f32_16x16x32_bf16 v[108:111], v[196:199], a[120:123], v[108:111]
    s_waitcnt vmcnt(21)
    v_mfma_f32_16x16x32_bf16 v[112:115], v[232:235], a[200:203], v[112:115]
    v_mfma_f32_16x16x32_bf16 v[112:115], v[176:179], a[196:199], v[112:115]
    v_mfma_f32_16x16x32_bf16 v[116:119], v[180:183], a[196:199], v[116:119]
    v_mfma_f32_16x16x32_bf16 v[116:119], v[236:239], a[200:203], v[116:119]
    v_mfma_f32_16x16x32_bf16 v[120:123], v[224:227], a[200:203], v[120:123]
    v_mfma_f32_16x16x32_bf16 v[120:123], v[148:151], a[196:199], v[120:123]
    v_mfma_f32_16x16x32_bf16 v[124:127], v[152:155], a[196:199], v[124:127]
    s_waitcnt lgkmcnt(0)
    v_add_f32 v13, v144, v189
    v_add_f32 v14, v146, v191
    v_mfma_f32_16x16x32_bf16 v[124:127], v[196:199], a[200:203], v[124:127]
    s_waitcnt vmcnt(19)
    v_readfirstlane_b32 s42, v15
    v_add_f32 v240, v168, v157
    v_add_f32 v242, v170, v159
    v_mfma_f32_16x16x32_bf16 v[128:131], v[232:235], a[192:195], v[128:131]
    v_add_f32 v240, v240, v13
    v_add_f32 v242, v242, v14
    v_mfma_f32_16x16x32_bf16 v[128:131], v[176:179], a[188:191], v[128:131]
    v_add_f32_dpp v240, v240, v240 row_ror:8 row_mask:0xf bank_mask:0xf
    v_add_f32_dpp v242, v242, v242 row_ror:8 row_mask:0xf bank_mask:0xf
    v_mfma_f32_16x16x32_bf16 v[132:135], v[180:183], a[188:191], v[132:135]
    v_add_f32_dpp v240, v240, v240 row_ror:4 row_mask:0xf bank_mask:0xf
    v_add_f32_dpp v242, v242, v242 row_ror:4 row_mask:0xf bank_mask:0xf
    s_cmp_lg_u32 s42, 0
    s_cbranch_scc1 L_goslow
    v_mfma_f32_16x16x32_bf16 v[132:135], v[236:239], a[192:195], v[132:135]
    v_mfma_f32_16x16x32_bf16 v[136:139], v[224:227], a[192:195], v[136:139]
    v_mfma_f32_16x16x32_bf16 v[136:139], v[148:151], a[188:191], v[136:139]
    v_mfma_f32_16x16x32_bf16 v[140:143], v[152:155], a[188:191], v[140:143]
    v_mfma_f32_16x16x32_bf16 v[140:143], v[196:199], a[192:195], v[140:143]
    s_waitcnt vmcnt(17)
    v_mfma_f32_16x16x32_bf16 v[84:87], v[228:231], a[92:95], v[84:87]
    v_mfma_f32_16x16x32_bf16 v[84:87], v[160:163], a[96:99], v[84:87]
    v_mfma_f32_16x16x32_bf16 v[80:83], v[208:211], a[96:99], v[80:83]
    v_mfma_f32_16x16x32_bf16 v[80:83], v[172:175], a[92:95], v[80:83]
    s_waitcnt vmcnt(15)
    v_mfma_f32_16x16x32_bf16 v[100:103], v[228:231], a[100:103], v[100:103]
    v_mfma_f32_16x16x32_bf16 v[100:103], v[160:163], a[104:107], v[100:103]
    v_mfma_f32_16x16x32_bf16 v[96:99], v[208:211], a[104:107], v[96:99]
    v_mfma_f32_16x16x32_bf16 v[96:99], v[172:175], a[100:103], v[96:99]
    s_waitcnt vmcnt(13)
    v_mfma_f32_16x16x32_bf16 v[116:119], v[228:231], a[132:135], v[116:119]
    v_mfma_f32_16x16x32_bf16 v[116:119], v[160:163], a[136:139], v[116:119]
    v_cvt_pk_bf16_f32 v84, v84, v85
    v_cvt_pk_bf16_f32 v85, v86, v87
    v_mfma_f32_16x16x32_bf16 v[112:115], v[208:211], a[136:139], v[112:115]
    v_cvt_pk_bf16_f32 v100, v100, v101
    v_cvt_pk_bf16_f32 v101, v102, v103
    v_mfma_f32_16x16x32_bf16 v[112:115], v[172:175], a[132:135], v[112:115]
    s_waitcnt vmcnt(11)
    ds_write2st64_b64 v7, v[84:85], v[100:101] offset0:0 offset1:2
    v_cvt_pk_bf16_f32 v80, v80, v81
    v_cvt_pk_bf16_f32 v81, v82, v83
    v_mfma_f32_16x16x32_bf16 v[132:135], v[228:231], a[124:127], v[132:135]
    v_cvt_pk_bf16_f32 v96, v96, v97
    v_cvt_pk_bf16_f32 v97, v98, v99
    v_mfma_f32_16x16x32_bf16 v[132:135], v[160:163], a[128:131], v[132:135]
    ds_write2st64_b64 v5, v[80:81], v[96:97] offset0:0 offset1:2
    v_mfma_f32_16x16x32_bf16 v[128:131], v[208:211], a[128:131], v[128:131]
    v_mfma_f32_16x16x32_bf16 v[128:131], v[172:175], a[124:127], v[128:131]
    s_waitcnt vmcnt(9)
    v_mfma_f32_16x16x32_bf16 v[20:23], v[228:231], a[140:143], v[20:23]
    s_waitcnt vmcnt(8)
    v_mfma_f32_16x16x32_bf16 v[20:23], v[160:163], a[144:147], v[20:23]
    s_waitcnt vmcnt(7)
    v_cvt_pk_bf16_f32 v116, v116, v117
    v_cvt_pk_bf16_f32 v117, v118, v119
    v_mfma_f32_16x16x32_bf16 v[36:39], v[160:163], a[148:151], v[36:39]
    s_waitcnt vmcnt(6)
    v_cvt_pk_bf16_f32 v132, v132, v133
    v_cvt_pk_bf16_f32 v133, v134, v135
    v_mfma_f32_16x16x32_bf16 v[36:39], v[228:231], a[152:155], v[36:39]
    s_waitcnt vmcnt(5)
    ds_write2st64_b64 v7, v[116:117], v[132:133] offset0:4 offset1:6
    v_cvt_pk_bf16_f32 v112, v112, v113
    v_cvt_pk_bf16_f32 v113, v114, v115
    v_mfma_f32_16x16x32_bf16 v[52:55], v[228:231], a[164:167], v[52:55]
    s_waitcnt vmcnt(4)
    v_cvt_pk_bf16_f32 v128, v128, v129
    v_cvt_pk_bf16_f32 v129, v130, v131
    v_mfma_f32_16x16x32_bf16 v[52:55], v[160:163], a[168:171], v[52:55]
    s_waitcnt vmcnt(3)
    ds_write2st64_b64 v5, v[112:113], v[128:129] offset0:4 offset1:6
    v_mfma_f32_16x16x32_bf16 v[68:71], v[160:163], a[156:159], v[68:71]
    v_mfma_f32_16x16x32_bf16 v[68:71], v[228:231], a[160:163], v[68:71]
    v_cvt_pk_bf16_f32 v20, v20, v21
    v_cvt_pk_bf16_f32 v21, v22, v23
    v_mfma_f32_16x16x32_bf16 v[16:19], v[172:175], a[140:143], v[16:19]
    v_cvt_pk_bf16_f32 v22, v36, v37
    v_cvt_pk_bf16_f32 v23, v38, v39
    v_mfma_f32_16x16x32_bf16 v[16:19], v[208:211], a[144:147], v[16:19]
    ds_write_b128 v6, v[20:23] offset:4096
    v_mfma_f32_16x16x32_bf16 v[32:35], v[208:211], a[148:151], v[32:35]
    v_mfma_f32_16x16x32_bf16 v[32:35], v[172:175], a[152:155], v[32:35]
    v_cvt_pk_bf16_f32 v52, v52, v53
    v_cvt_pk_bf16_f32 v53, v54, v55
    v_mfma_f32_16x16x32_bf16 v[48:51], v[172:175], a[164:167], v[48:51]
    v_cvt_pk_bf16_f32 v54, v68, v69
    v_cvt_pk_bf16_f32 v55, v70, v71
    v_mfma_f32_16x16x32_bf16 v[48:51], v[208:211], a[168:171], v[48:51]
    ds_write_b128 v6, v[52:55] offset:5120
    v_mfma_f32_16x16x32_bf16 v[64:67], v[208:211], a[156:159], v[64:67]
    v_mfma_f32_16x16x32_bf16 v[64:67], v[172:175], a[160:163], v[64:67]
    v_mfma_f32_16x16x32_bf16 v[92:95], v[184:187], a[92:95], v[92:95]
    s_waitcnt lgkmcnt(0)
    s_barrier
    ds_read_b128 v[20:23], v4 offset:0
    ds_read_b128 v[84:87], v4 offset:4096
    v_mfma_f32_16x16x32_bf16 v[92:95], v[212:215], a[96:99], v[92:95]
    ds_read_b128 v[36:39], v4 offset:1024
    ds_read_b128 v[52:55], v4 offset:2048
    v_mfma_f32_16x16x32_bf16 v[88:91], v[164:167], a[96:99], v[88:91]
    ds_read_b128 v[100:103], v4 offset:5120
    ds_read_b128 v[68:71], v4 offset:3072
    v_mfma_f32_16x16x32_bf16 v[88:91], v[200:203], a[92:95], v[88:91]
    v_mfma_f32_16x16x32_bf16 v[108:111], v[184:187], a[100:103], v[108:111]
    v_mfma_f32_16x16x32_bf16 v[108:111], v[212:215], a[104:107], v[108:111]
    v_mfma_f32_16x16x32_bf16 v[104:107], v[164:167], a[104:107], v[104:107]
    s_waitcnt lgkmcnt(5)
    v_mfma_f32_16x16x32_bf16 v[16:19], a[70:73], v[20:23], v[16:19]
    v_mov_b32 v128, v240
    v_xor_b32 v3, 0x800, v11
    s_waitcnt lgkmcnt(4)
    v_mfma_f32_16x16x32_bf16 v[16:19], a[64:67], v[84:87], v[16:19]
    v_mov_b32_dpp v128, v248 quad_perm:[0,1,2,3] row_mask:0xf bank_mask:0x2
    v_add_u32 v129, s37, v128
    v_mfma_f32_16x16x32_bf16 v[32:35], a[68:71], v[84:87], v[32:35]
    s_xor_b32 s43, s36, s37
    s_waitcnt lgkmcnt(3)
    v_mfma_f32_16x16x32_bf16 v[32:35], a[70:73], v[36:39], v[32:35]
    s_cmp_lg_u32 s43, s53
    s_cbranch_scc1 L_sendfar
    s_waitcnt lgkmcnt(2)
    v_mfma_f32_16x16x32_bf16 v[48:51], a[70:73], v[52:55], v[48:51]
    s_nop 0
    s_nop 0
    s_waitcnt lgkmcnt(1)
    v_mfma_f32_16x16x32_bf16 v[48:51], a[64:67], v[100:103], v[48:51]
    v_cvt_pk_bf16_f32 v96, v16, v17
    v_cvt_pk_bf16_f32 v97, v18, v19
    v_mfma_f32_16x16x32_bf16 v[64:67], a[68:71], v[100:103], v[64:67]
    v_cvt_pk_bf16_f32 v98, v32, v33
    v_cvt_pk_bf16_f32 v99, v34, v35
    s_waitcnt lgkmcnt(0)
    v_mfma_f32_16x16x32_bf16 v[64:67], a[70:73], v[68:71], v[64:67]
    v_add3_u32 v129, v129, v96, v97
    v_xor_b32 v96, s37, v96
    v_mfma_f32_16x16x32_bf16 v[104:107], v[200:203], a[100:103], v[104:107]
    global_store_dwordx4 v2, v[96:99], s[26:27] offset:0
    v_add3_u32 v129, v129, v98, v99
    v_mfma_f32_16x16x32_bf16 v[124:127], v[184:187], a[132:135], v[124:127]
    v_cvt_pk_bf16_f32 v112, v48, v49
    v_cvt_pk_bf16_f32 v113, v50, v51
    v_mfma_f32_16x16x32_bf16 v[124:127], v[212:215], a[136:139], v[124:127]
    v_cvt_pk_bf16_f32 v114, v64, v65
    v_cvt_pk_bf16_f32 v115, v66, v67
    v_mfma_f32_16x16x32_bf16 v[120:123], v[164:167], a[136:139], v[120:123]
    v_add3_u32 v129, v129, v112, v113
    v_xor_b32 v112, s37, v112
    v_mfma_f32_16x16x32_bf16 v[120:123], v[200:203], a[132:135], v[120:123]
    global_store_dwordx4 v2, v[112:115], s[26:27] offset:2048
    v_add3_u32 v129, v129, v114, v115
    global_store_dwordx2 v3, v[128:129], s[30:31]
L_sent:
    v_mfma_f32_16x16x32_bf16 v[140:143], v[184:187], a[124:127], v[140:143]
    v_cvt_pk_bf16_f32 v92, v92, v93
    v_cvt_pk_bf16_f32 v93, v94, v95
    v_mfma_f32_16x16x32_bf16 v[140:143], v[212:215], a[128:131], v[140:143]
    v_cvt_pk_bf16_f32 v108, v108, v109
    v_cvt_pk_bf16_f32 v109, v110, v111
    v_mfma_f32_16x16x32_bf16 v[136:139], v[164:167], a[128:131], v[136:139]
    ds_write2st64_b64 v7, v[92:93], v[108:109] offset0:64 offset1:66
    v_cvt_pk_bf16_f32 v88, v88, v89
    v_cvt_pk_bf16_f32 v89, v90, v91
    v_mfma_f32_16x16x32_bf16 v[136:139], v[200:203], a[124:127], v[136:139]
    v_cvt_pk_bf16_f32 v104, v104, v105
    v_cvt_pk_bf16_f32 v105, v106, v107
    v_mfma_f32_16x16x32_bf16 v[28:31], v[184:187], a[140:143], v[28:31]
    ds_write2st64_b64 v5, v[88:89], v[104:105] offset0:64 offset1:66
    v_mfma_f32_16x16x32_bf16 v[28:31], v[212:215], a[144:147], v[28:31]
    v_cvt_pk_bf16_f32 v124, v124, v125
    v_cvt_pk_bf16_f32 v125, v126, v127
    v_mfma_f32_16x16x32_bf16 v[44:47], v[212:215], a[148:151], v[44:47]
    v_cvt_pk_bf16_f32 v140, v140, v141
    v_cvt_pk_bf16_f32 v141, v142, v143
    v_mfma_f32_16x16x32_bf16 v[44:47], v[184:187], a[152:155], v[44:47]
    ds_write2st64_b64 v7, v[124:125], v[140:141] offset0:68 offset1:70
    v_cvt_pk_bf16_f32 v120, v120, v121
    v_cvt_pk_bf16_f32 v121, v122, v123
    v_mfma_f32_16x16x32_bf16 v[60:63], v[184:187], a[164:167], v[60:63]
    v_cvt_pk_bf16_f32 v136, v136, v137
    v_cvt_pk_bf16_f32 v137, v138, v139
    v_mfma_f32_16x16x32_bf16 v[60:63], v[212:215], a[168:171], v[60:63]
    ds_write2st64_b64 v5, v[120:121], v[136:137] offset0:68 offset1:70
    v_mfma_f32_16x16x32_bf16 v[76:79], v[212:215], a[156:159], v[76:79]
    v_mfma_f32_16x16x32_bf16 v[76:79], v[184:187], a[160:163], v[76:79]
    v_cvt_pk_bf16_f32 v28, v28, v29
    v_cvt_pk_bf16_f32 v29, v30, v31
    v_mfma_f32_16x16x32_bf16 v[24:27], v[200:203], a[140:143], v[24:27]
    v_cvt_pk_bf16_f32 v30, v44, v45
    v_cvt_pk_bf16_f32 v31, v46, v47
    v_mfma_f32_16x16x32_bf16 v[24:27], v[164:167], a[144:147], v[24:27]
    ds_write_b128 v6, v[28:31] offset:36864
    v_mfma_f32_16x16x32_bf16 v[40:43], v[164:167], a[148:151], v[40:43]
    v_mfma_f32_16x16x32_bf16 v[40:43], v[200:203], a[152:155], v[40:43]
    v_cvt_pk_bf16_f32 v60, v60, v61
    v_cvt_pk_bf16_f32 v61, v62, v63
    v_mfma_f32_16x16x32_bf16 v[56:59], v[200:203], a[164:167], v[56:59]
    v_cvt_pk_bf16_f32 v62, v76, v77
    v_cvt_pk_bf16_f32 v63, v78, v79
    v_mfma_f32_16x16x32_bf16 v[56:59], v[164:167], a[168:171], v[56:59]
    ds_write_b128 v6, v[60:63] offset:37888
    v_mfma_f32_16x16x32_bf16 v[72:75], v[164:167], a[156:159], v[72:75]
    v_mfma_f32_16x16x32_bf16 v[72:75], v[200:203], a[160:163], v[72:75]
    s_waitcnt lgkmcnt(0)
    s_barrier
    ds_read_b128 v[20:23], v4 offset:32768
    ds_read_b128 v[36:39], v4 offset:33792
    ds_read_b128 v[52:55], v4 offset:34816
    ds_read_b128 v[68:71], v4 offset:35840
    ds_read_b128 v[84:87], v4 offset:36864
    ds_read_b128 v[100:103], v4 offset:37888
    global_load_dwordx4 v[16:19], v12, s[26:27] sc1
    global_load_dwordx4 v[32:35], v12, s[26:27] offset:2048 sc1
    global_load_dwordx2 v[48:49], v11, s[30:31] sc1
L_comb:
    s_waitcnt lgkmcnt(5)
    v_mfma_f32_16x16x32_bf16 v[24:27], a[70:73], v[20:23], v[24:27]
    s_waitcnt lgkmcnt(4)
    v_mfma_f32_16x16x32_bf16 v[40:43], a[70:73], v[36:39], v[40:43]
    s_waitcnt lgkmcnt(3)
    v_mfma_f32_16x16x32_bf16 v[56:59], a[70:73], v[52:55], v[56:59]
    s_waitcnt lgkmcnt(2)
    v_mfma_f32_16x16x32_bf16 v[72:75], a[70:73], v[68:71], v[72:75]
    s_waitcnt lgkmcnt(1)
    v_mfma_f32_16x16x32_bf16 v[24:27], a[64:67], v[84:87], v[24:27]
    v_mfma_f32_16x16x32_bf16 v[40:43], a[68:71], v[84:87], v[40:43]
    s_waitcnt lgkmcnt(0)
    v_mfma_f32_16x16x32_bf16 v[56:59], a[64:67], v[100:103], v[56:59]
    v_mfma_f32_16x16x32_bf16 v[72:75], a[68:71], v[100:103], v[72:75]
L_xpoll:
    s_waitcnt vmcnt(0)
    v_xor_b32 v16, s37, v16
    v_xor_b32 v32, s37, v32
    v_add_f32 v9, v242, v48
    v_mfma_f32_16x16x32_bf16 v[144:147], a[64:67], v[16:19], v[24:27]
    v_rcp_f32 v9, v9
    v_mfma_f32_16x16x32_bf16 v[148:151], a[68:71], v[16:19], v[40:43]
    v_add3_u32 v14, v16, v17, s37
    v_add3_u32 v15, v18, v19, v32
    v_mfma_f32_16x16x32_bf16 v[152:155], a[64:67], v[32:35], v[56:59]
    v_add3_u32 v14, v14, v33, v34
    v_add3_u32 v15, v15, v35, v48
    v_mfma_f32_16x16x32_bf16 v[156:159], a[68:71], v[32:35], v[72:75]
    v_add_u32 v14, v14, v15
    v_cmp_ne_u32 s[42:43], v250, v48
    v_cmp_ne_u32 vcc, v14, v49
    v_mov_b32_dpp v168, v9 row_newbcast:0 row_mask:0xf bank_mask:0xf
    v_mov_b32_dpp v169, v9 row_newbcast:1 row_mask:0xf bank_mask:0xf
    v_mov_b32_dpp v170, v9 row_newbcast:2 row_mask:0xf bank_mask:0xf
    v_mov_b32_dpp v171, v9 row_newbcast:3 row_mask:0xf bank_mask:0xf
    s_cbranch_vccnz L_xretry
L_xdone:
    s_and_b64 s[42:43], s[42:43], s[12:13]
    s_cbranch_scc1 L_general
    v_pk_mul_f32 v[144:145], v[144:145], v[168:169]
    v_pk_mul_f32 v[146:147], v[146:147], v[170:171]
    v_pk_mul_f32 v[148:149], v[148:149], v[168:169]
    v_pk_mul_f32 v[150:151], v[150:151], v[170:171]
    v_pk_mul_f32 v[152:153], v[152:153], v[168:169]
    v_pk_mul_f32 v[154:155], v[154:155], v[170:171]
    v_pk_mul_f32 v[156:157], v[156:157], v[168:169]
    v_pk_mul_f32 v[158:159], v[158:159], v[170:171]
    v_cvt_pk_bf16_f32 v160, v144, v148
    v_cvt_pk_bf16_f32 v161, v152, v156
    global_store_dwordx2 v1, v[160:161], s[6:7] offset:0 nt
    v_cvt_pk_bf16_f32 v162, v145, v149
    v_cvt_pk_bf16_f32 v163, v153, v157
    global_store_dwordx2 v1, v[162:163], s[6:7] offset:256 nt
    v_cvt_pk_bf16_f32 v164, v146, v150
    v_cvt_pk_bf16_f32 v165, v154, v158
    global_store_dwordx2 v1, v[164:165], s[6:7] offset:512 nt
    v_cvt_pk_bf16_f32 v166, v147, v151
    v_cvt_pk_bf16_f32 v167, v155, v159
    global_store_dwordx2 v1, v[166:167], s[6:7] offset:768 nt
L_fin:
    s_cmp_eq_u32 s2, 0
    s_cbranch_scc1 L_bump
L_fin2:
L_end:
    s_endpgm
L_xretry:
    s_sub_u32 s46, s46, 1
    s_cbranch_scc1 L_xdone
    global_load_dwordx4 v[16:19], v12, s[26:27] sc1
    global_load_dwordx4 v[32:35], v12, s[26:27] offset:2048 sc1
    global_load_dwordx2 v[48:49], v11, s[30:31] sc1
    s_branch L_xpoll
L_general:
    v_max_f32 v5, v250, v48
    v_sub_f32 v14, v250, v5
    v_sub_f32 v15, v48, v5
    s_nop 1
    v_mov_b32_dpp v6, v14 row_ror:12 row_mask:0xf bank_mask:0xf
    v_mov_b32_dpp v7, v15 row_ror:12 row_mask:0xf bank_mask:0xf
    v_exp_f32 v6, v6
    v_exp_f32 v7, v7
    s_nop 0
    v_mul_f32 v9, v6, v242
    v_fmac_f32 v9, v7, v48
    v_rcp_f32 v9, v9
    s_nop 0
    v_mul_f32 v6, v6, v9
    v_mul_f32 v7, v7, v9
    s_nop 1
    v_mov_b32_dpp v168, v6 row_newbcast:0 row_mask:0xf bank_mask:0xf
    v_mov_b32_dpp v172, v7 row_newbcast:0 row_mask:0xf bank_mask:0xf
    v_mov_b32_dpp v169, v6 row_newbcast:1 row_mask:0xf bank_mask:0xf
    v_mov_b32_dpp v173, v7 row_newbcast:1 row_mask:0xf bank_mask:0xf
    v_mov_b32_dpp v170, v6 row_newbcast:2 row_mask:0xf bank_mask:0xf
    v_mov_b32_dpp v174, v7 row_newbcast:2 row_mask:0xf bank_mask:0xf
    v_mov_b32_dpp v171, v6 row_newbcast:3 row_mask:0xf bank_mask:0xf
    v_mov_b32_dpp v175, v7 row_newbcast:3 row_mask:0xf bank_mask:0xf
    v_lshlrev_b32 v144, 16, v16
    v_and_b32 v145, 0xffff0000, v16
    v_mul_f32 v144, v144, v172
    v_mul_f32 v145, v145, v173
    v_fmac_f32 v144, v24, v168
    v_fmac_f32 v145, v25, v169
    v_lshlrev_b32 v146, 16, v17
    v_and_b32 v147, 0xffff0000, v17
    v_mul_f32 v146, v146, v174
    v_mul_f32 v147, v147, v175
    v_fmac_f32 v146, v26, v170
    v_fmac_f32 v147, v27, v171
    v_lshlrev_b32 v148, 16, v18
    v_and_b32 v149, 0xffff0000, v18
    v_mul_f32 v148, v148, v172
    v_mul_f32 v149, v149, v173
    v_fmac_f32 v148, v40, v168
    v_fmac_f32 v149, v41, v169
    v_lshlrev_b32 v150, 16, v19
    v_and_b32 v151, 0xffff0000, v19
    v_mul_f32 v150, v150, v174
    v_mul_f32 v151, v151, v175
    v_fmac_f32 v150, v42, v170
    v_fmac_f32 v151, v43, v171
    v_lshlrev_b32 v152, 16, v32
    v_and_b32 v153, 0xffff0000, v32
    v_mul_f32 v152, v152, v172
    v_mul_f32 v153, v153, v173
    v_fmac_f32 v152, v56, v168
    v_fmac_f32 v153, v57, v169
    v_lshlrev_b32 v154, 16, v33
    v_and_b32 v155, 0xffff0000, v33
    v_mul_f32 v154, v154, v174
    v_mul_f32 v155, v155, v175
    v_fmac_f32 v154, v58, v170
    v_fmac_f32 v155, v59, v171
    v_lshlrev_b32 v156, 16, v34
    v_and_b32 v157, 0xffff0000, v34
    v_mul_f32 v156, v156, v172
    v_mul_f32 v157, v157, v173
    v_fmac_f32 v156, v72, v168
    v_fmac_f32 v157, v73, v169
    v_lshlrev_b32 v158, 16, v35
    v_and_b32 v159, 0xffff0000, v35
    v_mul_f32 v158, v158, v174
    v_mul_f32 v159, v159, v175
    v_fmac_f32 v158, v74, v170
    v_fmac_f32 v159, v75, v171
    v_cvt_pk_bf16_f32 v160, v144, v148
    v_cvt_pk_bf16_f32 v161, v152, v156
    global_store_dwordx2 v1, v[160:161], s[6:7] offset:0 nt
    v_cvt_pk_bf16_f32 v162, v145, v149
    v_cvt_pk_bf16_f32 v163, v153, v157
    global_store_dwordx2 v1, v[162:163], s[6:7] offset:256 nt
    v_cvt_pk_bf16_f32 v164, v146, v150
    v_cvt_pk_bf16_f32 v165, v154, v158
    global_store_dwordx2 v1, v[164:165], s[6:7] offset:512 nt
    v_cvt_pk_bf16_f32 v166, v147, v151
    v_cvt_pk_bf16_f32 v167, v155, v159
    global_store_dwordx2 v1, v[166:167], s[6:7] offset:768 nt
    s_branch L_fin
L_sendfar:
    s_nop 3
    s_waitcnt lgkmcnt(2)
    v_mfma_f32_16x16x32_bf16 v[48:51], a[70:73], v[52:55], v[48:51]
    s_nop 0
    s_nop 0
    s_waitcnt lgkmcnt(1)
    v_mfma_f32_16x16x32_bf16 v[48:51], a[64:67], v[100:103], v[48:51]
    v_cvt_pk_bf16_f32 v96, v16, v17
    v_cvt_pk_bf16_f32 v97, v18, v19
    v_mfma_f32_16x16x32_bf16 v[64:67], a[68:71], v[100:103], v[64:67]
    v_cvt_pk_bf16_f32 v98, v32, v33
    v_cvt_pk_bf16_f32 v99, v34, v35
    s_waitcnt lgkmcnt(0)
    v_mfma_f32_16x16x32_bf16 v[64:67], a[70:73], v[68:71], v[64:67]
    v_add3_u32 v129, v129, v96, v97
    v_xor_b32 v96, s37, v96
    v_mfma_f32_16x16x32_bf16 v[104:107], v[200:203], a[100:103], v[104:107]
    global_store_dwordx4 v2, v[96:99], s[26:27] offset:0 sc1
    v_add3_u32 v129, v129, v98, v99
    v_mfma_f32_16x16x32_bf16 v[124:127], v[184:187], a[132:135], v[124:127]
    v_cvt_pk_bf16_f32 v112, v48, v49
    v_cvt_pk_bf16_f32 v113, v50, v51
    v_mfma_f32_16x16x32_bf16 v[124:127], v[212:215], a[136:139], v[124:127]
    v_cvt_pk_bf16_f32 v114, v64, v65
    v_cvt_pk_bf16_f32 v115, v66, v67
    v_mfma_f32_16x16x32_bf16 v[120:123], v[164:167], a[136:139], v[120:123]
    v_add3_u32 v129, v129, v112, v113
    v_xor_b32 v112, s37, v112
    v_mfma_f32_16x16x32_bf16 v[120:123], v[200:203], a[132:135], v[120:123]
    global_store_dwordx4 v2, v[112:115], s[26:27] offset:2048 sc1
    v_add3_u32 v129, v129, v114, v115
    global_store_dwordx2 v3, v[128:129], s[30:31] sc1
    s_branch L_sent
L_bump:
    s_cbranch_execz L_hookdone
    v_accvgpr_read_b32 v9, a207
    v_mov_b32 v14, 26624
    v_mov_b32 v15, 1
L_epoch1:
    v_cmp_ne_u32 vcc, s37, v9
    s_cbranch_vccnz L_epoch3
L_epoch2:
    s_mov_b64 exec, 1
    ds_add_rtn_u32 v13, v14, v15 offset:4
    v_mov_b32 v9, 4227072
    v_mov_b32 v10, s37
    s_waitcnt lgkmcnt(0)
    v_cmp_eq_u32 vcc, 3, v13
    s_cbranch_vccz L_epoch4
    global_store_dword v9, v10, s[30:31]
L_epoch4:
    s_mov_b64 exec, -1
    s_branch L_fin2
L_epoch3:
    s_sub_u32 s46, s46, 1
    s_cbranch_scc1 L_epoch2
    s_lshl_b32 s40, s35, 6
    v_add_u32 v13, s40, v0
    v_lshlrev_b32 v13, 11, v13
    v_add_u32 v13, 4260740, v13
    global_load_dword v9, v13, s[30:31] sc1
    s_waitcnt vmcnt(0)
    s_branch L_epoch1
L_codeend:
L_setflag:
    v_mov_b32 v14, 26624
    v_mov_b32 v15, 1
    ds_write_b32 v14, v15
    s_branch L_flagset
L_goslow:
    s_waitcnt vmcnt(0) lgkmcnt(0)
    s_not_b32 s40, s37
    v_mov_b32 v13, s40
    v_accvgpr_write_b32 a207, v13
    v_mov_b32 v248, 0xff800000
    v_mov_b32 v249, 0xff800000
    v_mov_b32 v250, 0xff800000
    v_mov_b32 v251, 0xff800000
    s_mov_b32 s48, s54
    s_mov_b32 s49, s55
    s_mov_b32 s50, 0
L_slow0:
    global_load_dwordx4 a[92:95], v244, s[48:49] offset:0 sc1
    global_load_dwordx4 a[96:99], v244, s[48:49] offset:1024 sc1
    global_load_dwordx4 a[100:103], v244, s[48:49] offset:2048 sc1
    global_load_dwordx4 a[104:107], v244, s[48:49] offset:3072 sc1
    global_load_dwordx4 a[108:111], v245, s[48:49] offset:0 sc1
    global_load_dwordx4 a[112:115], v245, s[48:49] offset:1024 sc1
    global_load_dwordx4 a[116:119], v245, s[48:49] offset:2048 sc1
    global_load_dwordx4 a[120:123], v245, s[48:49] offset:3072 sc1
    s_waitcnt vmcnt(0)
    v_mfma_f32_16x16x32_bf16 v[144:147], a[92:95], a[0:3], 0
    v_mfma_f32_16x16x32_bf16 v[148:151], a[92:95], a[16:19], 0
    v_mfma_f32_16x16x32_bf16 v[152:155], a[92:95], a[32:35], 0
    v_mfma_f32_16x16x32_bf16 v[156:159], a[92:95], a[48:51], 0
    v_mfma_f32_16x16x32_bf16 v[144:147], a[96:99], a[4:7], v[144:147]
    v_mfma_f32_16x16x32_bf16 v[148:151], a[96:99], a[20:23], v[148:151]
    v_mfma_f32_16x16x32_bf16 v[152:155], a[96:99], a[36:39], v[152:155]
    v_mfma_f32_16x16x32_bf16 v[156:159], a[96:99], a[52:55], v[156:159]
    v_mfma_f32_16x16x32_bf16 v[144:147], a[100:103], a[8:11], v[144:147]
    v_mfma_f32_16x16x32_bf16 v[148:151], a[100:103], a[24:27], v[148:151]
    v_mfma_f32_16x16x32_bf16 v[152:155], a[100:103], a[40:43], v[152:155]
    v_mfma_f32_16x16x32_bf16 v[156:159], a[100:103], a[56:59], v[156:159]
    v_mfma_f32_16x16x32_bf16 v[144:147], a[104:107], a[12:15], v[144:147]
    v_mfma_f32_16x16x32_bf16 v[148:151], a[104:107], a[28:31], v[148:151]
    v_mfma_f32_16x16x32_bf16 v[152:155], a[104:107], a[44:47], v[152:155]
    v_mfma_f32_16x16x32_bf16 v[156:159], a[104:107], a[60:63], v[156:159]
    v_mfma_f32_16x16x32_bf16 v[160:163], a[108:111], a[0:3], 0
    v_mfma_f32_16x16x32_bf16 v[164:167], a[108:111], a[16:19], 0
    v_mfma_f32_16x16x32_bf16 v[168:171], a[108:111], a[32:35], 0
    v_mfma_f32_16x16x32_bf16 v[172:175], a[108:111], a[48:51], 0
    v_mfma_f32_16x16x32_bf16 v[160:163], a[112:115], a[4:7], v[160:163]
    v_mfma_f32_16x16x32_bf16 v[164:167], a[112:115], a[20:23], v[164:167]
    v_mfma_f32_16x16x32_bf16 v[168:171], a[112:115], a[36:39], v[168:171]
    v_mfma_f32_16x16x32_bf16 v[172:175], a[112:115], a[52:55], v[172:175]
    v_mfma_f32_16x16x32_bf16 v[160:163], a[116:119], a[8:11], v[160:163]
    v_mfma_f32_16x16x32_bf16 v[164:167], a[116:119], a[24:27], v[164:167]
    v_mfma_f32_16x16x32_bf16 v[168:171], a[116:119], a[40:43], v[168:171]
    v_mfma_f32_16x16x32_bf16 v[172:175], a[116:119], a[56:59], v[172:175]
    v_mfma_f32_16x16x32_bf16 v[160:163], a[120:123], a[12:15], v[160:163]
    v_mfma_f32_16x16x32_bf16 v[164:167], a[120:123], a[28:31], v[164:167]
    v_mfma_f32_16x16x32_bf16 v[168:171], a[120:123], a[44:47], v[168:171]
    v_mfma_f32_16x16x32_bf16 v[172:175], a[120:123], a[60:63], v[172:175]
    s_nop 7
    v_max3_f32 v248, v248, v144, v145
    v_max3_f32 v248, v248, v146, v147
    v_max3_f32 v249, v249, v148, v149
    v_max3_f32 v249, v249, v150, v151
    v_max3_f32 v250, v250, v152, v153
    v_max3_f32 v250, v250, v154, v155
    v_max3_f32 v251, v251, v156, v157
    v_max3_f32 v251, v251, v158, v159
    v_max3_f32 v248, v248, v160, v161
    v_max3_f32 v248, v248, v162, v163
    v_max3_f32 v249, v249, v164, v165
    v_max3_f32 v249, v249, v166, v167
    v_max3_f32 v250, v250, v168, v169
    v_max3_f32 v250, v250, v170, v171
    v_max3_f32 v251, v251, v172, v173
    v_max3_f32 v251, v251, v174, v175
    s_add_u32 s48, s48, 0x4000
    s_addc_u32 s49, s49, 0
    s_add_u32 s50, s50, 1
    s_cmp_lt_u32 s50, 8
    s_cbranch_scc1 L_slow0
    s_lshr_b32 s40, s35, 1
    s_lshl_b32 s40, s40, 8
    s_add_u32 s41, s40, 27136
    v_lshl_add_u32 v14, v0, 2, s41
    v_xor_b32 v15, 0x100, v14
    s_lshl_b32 s41, s35, 10
    v_add_u32 v176, s41, v14
    v_add_u32 v177, s41, v15
    ds_write_b32 v176, v248 offset:0
    ds_write_b32 v177, v249 offset:0
    ds_write_b32 v176, v250 offset:512
    ds_write_b32 v177, v251 offset:512
    s_waitcnt lgkmcnt(0)
    s_barrier
    ds_read_b32 v144, v14 offset:0
    ds_read_b32 v145, v15 offset:0
    ds_read_b32 v146, v14 offset:512
    ds_read_b32 v147, v15 offset:512
    ds_read_b32 v148, v14 offset:1024
    ds_read_b32 v149, v15 offset:1024
    ds_read_b32 v150, v14 offset:1536
    ds_read_b32 v151, v15 offset:1536
    ds_read_b32 v152, v14 offset:2048
    ds_read_b32 v153, v15 offset:2048
    ds_read_b32 v154, v14 offset:2560
    ds_read_b32 v155, v15 offset:2560
    ds_read_b32 v156, v14 offset:3072
    ds_read_b32 v157, v15 offset:3072
    ds_read_b32 v158, v14 offset:3584
    ds_read_b32 v159, v15 offset:3584
    s_waitcnt lgkmcnt(0)
    v_max3_f32 v248, v144, v148, v152
    v_max_f32 v248, v248, v156
    v_max3_f32 v249, v145, v149, v153
    v_max_f32 v249, v249, v157
    v_max3_f32 v250, v146, v150, v154
    v_max_f32 v250, v250, v158
    v_max3_f32 v251, v147, v151, v155
    v_max_f32 v251, v251, v159
    v_mov_b32 v255, v248
    s_nop 1
    v_permlane32_swap_b32 v255, v248
    s_nop 1
    v_max_f32 v248, v248, v255
    v_mov_b32 v255, v248
    s_nop 1
    v_permlane16_swap_b32 v255, v248
    s_nop 1
    v_max_f32 v248, v248, v255
    v_mov_b32 v255, v249
    s_nop 1
    v_permlane32_swap_b32 v255, v249
    s_nop 1
    v_max_f32 v249, v249, v255
    v_mov_b32 v255, v249
    s_nop 1
    v_permlane16_swap_b32 v255, v249
    s_nop 1
    v_max_f32 v249, v249, v255
    v_mov_b32 v255, v250
    s_nop 1
    v_permlane32_swap_b32 v255, v250
    s_nop 1
    v_max_f32 v250, v250, v255
    v_mov_b32 v255, v250
    s_nop 1
    v_permlane16_swap_b32 v255, v250
    s_nop 1
    v_max_f32 v250, v250, v255
    v_mov_b32 v255, v251
    s_nop 1
    v_permlane32_swap_b32 v255, v251
    s_nop 1
    v_max_f32 v251, v251, v255
    v_mov_b32 v255, v251
    s_nop 1
    v_permlane16_swap_b32 v255, v251
    s_nop 1
    v_max_f32 v251, v251, v255
    v_mov_b32 v240, 0
    v_sub_f32 v224, 0, v248
    v_sub_f32 v225, 0, v248
    v_sub_f32 v226, 0, v248
    v_sub_f32 v227, 0, v248
    v_mov_b32 v241, 0
    v_sub_f32 v228, 0, v249
    v_sub_f32 v229, 0, v249
    v_sub_f32 v230, 0, v249
    v_sub_f32 v231, 0, v249
    v_mov_b32 v242, 0
    v_sub_f32 v232, 0, v250
    v_sub_f32 v233, 0, v250
    v_sub_f32 v234, 0, v250
    v_sub_f32 v235, 0, v250
    v_mov_b32 v243, 0
    v_sub_f32 v236, 0, v251
    v_sub_f32 v237, 0, v251
    v_sub_f32 v238, 0, v251
    v_sub_f32 v239, 0, v251
    v_mov_b32 v255, v248
    s_nop 1
    v_mov_b32_dpp v248, v255 row_ror:4 row_mask:0x1 bank_mask:0xf
    s_nop 1
    v_mov_b32_dpp v248, v255 row_ror:12 row_mask:0x4 bank_mask:0xf
    s_nop 1
    v_mov_b32_dpp v248, v255 row_ror:8 row_mask:0x8 bank_mask:0xf
    v_mov_b32 v255, v250
    s_nop 1
    v_mov_b32_dpp v250, v255 row_ror:4 row_mask:0x1 bank_mask:0xf
    s_nop 1
    v_mov_b32_dpp v250, v255 row_ror:12 row_mask:0x4 bank_mask:0xf
    s_nop 1
    v_mov_b32_dpp v250, v255 row_ror:8 row_mask:0x8 bank_mask:0xf
    v_mov_b32 v16, 0
    v_mov_b32 v17, 0
    v_mov_b32 v18, 0
    v_mov_b32 v19, 0
    v_mov_b32 v20, 0
    v_mov_b32 v21, 0
    v_mov_b32 v22, 0
    v_mov_b32 v23, 0
    v_mov_b32 v24, 0
    v_mov_b32 v25, 0
    v_mov_b32 v26, 0
    v_mov_b32 v27, 0
    v_mov_b32 v28, 0
    v_mov_b32 v29, 0
    v_mov_b32 v30, 0
    v_mov_b32 v31, 0
    v_mov_b32 v32, 0
    v_mov_b32 v33, 0
    v_mov_b32 v34, 0
    v_mov_b32 v35, 0
    v_mov_b32 v36, 0
    v_mov_b32 v37, 0
    v_mov_b32 v38, 0
    v_mov_b32 v39, 0
    v_mov_b32 v40, 0
    v_mov_b32 v41, 0
    v_mov_b32 v42, 0
    v_mov_b32 v43, 0
    v_mov_b32 v44, 0
    v_mov_b32 v45, 0
    v_mov_b32 v46, 0
    v_mov_b32 v47, 0
    v_mov_b32 v48, 0
    v_mov_b32 v49, 0
    v_mov_b32 v50, 0
    v_mov_b32 v51, 0
    v_mov_b32 v52, 0
    v_mov_b32 v53, 0
    v_mov_b32 v54, 0
    v_mov_b32 v55, 0
    v_mov_b32 v56, 0
    v_mov_b32 v57, 0
    v_mov_b32 v58, 0
    v_mov_b32 v59, 0
    v_mov_b32 v60, 0
    v_mov_b32 v61, 0
    v_mov_b32 v62, 0
    v_mov_b32 v63, 0
    v_mov_b32 v64, 0
    v_mov_b32 v65, 0
    v_mov_b32 v66, 0
    v_mov_b32 v67, 0
    v_mov_b32 v68, 0
    v_mov_b32 v69, 0
    v_mov_b32 v70, 0
    v_mov_b32 v71, 0
    v_mov_b32 v72, 0
    v_mov_b32 v73, 0
    v_mov_b32 v74, 0
    v_mov_b32 v75, 0
    v_mov_b32 v76, 0
    v_mov_b32 v77, 0
    v_mov_b32 v78, 0
    v_mov_b32 v79, 0
    v_mov_b32 v80, 0
    v_mov_b32 v81, 0
    v_mov_b32 v82, 0
    v_mov_b32 v83, 0
    v_mov_b32 v84, 0
    v_mov_b32 v85, 0
    v_mov_b32 v86, 0
    v_mov_b32 v87, 0
    v_mov_b32 v88, 0
    v_mov_b32 v89, 0
    v_mov_b32 v90, 0
    v_mov_b32 v91, 0
    v_mov_b32 v92, 0
    v_mov_b32 v93, 0
    v_mov_b32 v94, 0
    v_mov_b32 v95, 0
    v_mov_b32 v96, 0
    v_mov_b32 v97, 0
    v_mov_b32 v98, 0
    v_mov_b32 v99, 0
    v_mov_b32 v100, 0
    v_mov_b32 v101, 0
    v_mov_b32 v102, 0
    v_mov_b32 v103, 0
    v_mov_b32 v104, 0
    v_mov_b32 v105, 0
    v_mov_b32 v106, 0
    v_mov_b32 v107, 0
    v_mov_b32 v108, 0
    v_mov_b32 v109, 0
    v_mov_b32 v110, 0
    v_mov_b32 v111, 0
    v_mov_b32 v112, 0
    v_mov_b32 v113, 0
    v_mov_b32 v114, 0
    v_mov_b32 v115, 0
    v_mov_b32 v116, 0
    v_mov_b32 v117, 0
    v_mov_b32 v118, 0
    v_mov_b32 v119, 0
    v_mov_b32 v120, 0
    v_mov_b32 v121, 0
    v_mov_b32 v122, 0
    v_mov_b32 v123, 0
    v_mov_b32 v124, 0
    v_mov_b32 v125, 0
    v_mov_b32 v126, 0
    v_mov_b32 v127, 0
    v_mov_b32 v128, 0
    v_mov_b32 v129, 0
    v_mov_b32 v130, 0
    v_mov_b32 v131, 0
    v_mov_b32 v132, 0
    v_mov_b32 v133, 0
    v_mov_b32 v134, 0
    v_mov_b32 v135, 0
    v_mov_b32 v136, 0
    v_mov_b32 v137, 0
    v_mov_b32 v138, 0
    v_mov_b32 v139, 0
    v_mov_b32 v140, 0
    v_mov_b32 v141, 0
    v_mov_b32 v142, 0
    v_mov_b32 v143, 0
    s_mov_b32 s48, s54
    s_mov_b32 s49, s55
    s_mov_b32 s50, 0
L_slow1:
    global_load_dwordx4 a[92:95], v244, s[48:49] offset:0 sc1
    global_load_dwordx4 a[96:99], v244, s[48:49] offset:1024 sc1
    global_load_dwordx4 a[100:103], v244, s[48:49] offset:2048 sc1
    global_load_dwordx4 a[104:107], v244, s[48:49] offset:3072 sc1
    global_load_dwordx4 a[108:111], v245, s[48:49] offset:0 sc1
    global_load_dwordx4 a[112:115], v245, s[48:49] offset:1024 sc1
    global_load_dwordx4 a[116:119], v245, s[48:49] offset:2048 sc1
    global_load_dwordx4 a[120:123], v245, s[48:49] offset:3072 sc1
    global_load_dwordx4 a[124:127], v246, s[48:49] offset:0 sc1
    global_load_dwordx4 a[128:131], v246, s[48:49] offset:1024 sc1
    global_load_dwordx4 a[132:135], v246, s[48:49] offset:2048 sc1
    global_load_dwordx4 a[136:139], v246, s[48:49] offset:3072 sc1
    global_load_dwordx4 a[140:143], v247, s[48:49] offset:0 sc1
    global_load_dwordx4 a[144:147], v247, s[48:49] offset:1024 sc1
    global_load_dwordx4 a[148:151], v247, s[48:49] offset:2048 sc1
    global_load_dwordx4 a[152:155], v247, s[48:49] offset:3072 sc1
    s_waitcnt vmcnt(0)
    v_mfma_f32_16x16x32_bf16 v[144:147], a[92:95], a[0:3], v[224:227]
    v_mfma_f32_16x16x32_bf16 v[148:151], a[92:95], a[16:19], v[228:231]
    v_mfma_f32_16x16x32_bf16 v[152:155], a[92:95], a[32:35], v[232:235]
    v_mfma_f32_16x16x32_bf16 v[156:159], a[92:95], a[48:51], v[236:239]
    v_mfma_f32_16x16x32_bf16 v[144:147], a[96:99], a[4:7], v[144:147]
    v_mfma_f32_16x16x32_bf16 v[148:151], a[96:99], a[20:23], v[148:151]
    v_mfma_f32_16x16x32_bf16 v[152:155], a[96:99], a[36:39], v[152:155]
    v_mfma_f32_16x16x32_bf16 v[156:159], a[96:99], a[52:55], v[156:159]
    v_mfma_f32_16x16x32_bf16 v[144:147], a[100:103], a[8:11], v[144:147]
    v_mfma_f32_16x16x32_bf16 v[148:151], a[100:103], a[24:27], v[148:151]
    v_mfma_f32_16x16x32_bf16 v[152:155], a[100:103], a[40:43], v[152:155]
    v_mfma_f32_16x16x32_bf16 v[156:159], a[100:103], a[56:59], v[156:159]
    v_mfma_f32_16x16x32_bf16 v[144:147], a[104:107], a[12:15], v[144:147]
    v_mfma_f32_16x16x32_bf16 v[148:151], a[104:107], a[28:31], v[148:151]
    v_mfma_f32_16x16x32_bf16 v[152:155], a[104:107], a[44:47], v[152:155]
    v_mfma_f32_16x16x32_bf16 v[156:159], a[104:107], a[60:63], v[156:159]
    v_mfma_f32_16x16x32_bf16 v[160:163], a[108:111], a[0:3], v[224:227]
    v_mfma_f32_16x16x32_bf16 v[164:167], a[108:111], a[16:19], v[228:231]
    v_mfma_f32_16x16x32_bf16 v[168:171], a[108:111], a[32:35], v[232:235]
    v_mfma_f32_16x16x32_bf16 v[172:175], a[108:111], a[48:51], v[236:239]
    v_mfma_f32_16x16x32_bf16 v[160:163], a[112:115], a[4:7], v[160:163]
    v_mfma_f32_16x16x32_bf16 v[164:167], a[112:115], a[20:23], v[164:167]
    v_mfma_f32_16x16x32_bf16 v[168:171], a[112:115], a[36:39], v[168:171]
    v_mfma_f32_16x16x32_bf16 v[172:175], a[112:115], a[52:55], v[172:175]
    v_mfma_f32_16x16x32_bf16 v[160:163], a[116:119], a[8:11], v[160:163]
    v_mfma_f32_16x16x32_bf16 v[164:167], a[116:119], a[24:27], v[164:167]
    v_mfma_f32_16x16x32_bf16 v[168:171], a[116:119], a[40:43], v[168:171]
    v_mfma_f32_16x16x32_bf16 v[172:175], a[116:119], a[56:59], v[172:175]
    v_mfma_f32_16x16x32_bf16 v[160:163], a[120:123], a[12:15], v[160:163]
    v_mfma_f32_16x16x32_bf16 v[164:167], a[120:123], a[28:31], v[164:167]
    v_mfma_f32_16x16x32_bf16 v[168:171], a[120:123], a[44:47], v[168:171]
    v_mfma_f32_16x16x32_bf16 v[172:175], a[120:123], a[60:63], v[172:175]
    s_nop 7
    v_exp_f32 v144, v144
    v_exp_f32 v145, v145
    v_exp_f32 v146, v146
    v_exp_f32 v147, v147
    v_exp_f32 v148, v148
    v_exp_f32 v149, v149
    v_exp_f32 v150, v150
    v_exp_f32 v151, v151
    v_exp_f32 v152, v152
    v_exp_f32 v153, v153
    v_exp_f32 v154, v154
    v_exp_f32 v155, v155
    v_exp_f32 v156, v156
    v_exp_f32 v157, v157
    v_exp_f32 v158, v158
    v_exp_f32 v159, v159
    v_exp_f32 v160, v160
    v_exp_f32 v161, v161
    v_exp_f32 v162, v162
    v_exp_f32 v163, v163
    v_exp_f32 v164, v164
    v_exp_f32 v165, v165
    v_exp_f32 v166, v166
    v_exp_f32 v167, v167
    v_exp_f32 v168, v168
    v_exp_f32 v169, v169
    v_exp_f32 v170, v170
    v_exp_f32 v171, v171
    v_exp_f32 v172, v172
    v_exp_f32 v173, v173
    v_exp_f32 v174, v174
    v_exp_f32 v175, v175
    v_add_f32 v240, v240, v144
    v_add_f32 v240, v240, v145
    v_add_f32 v240, v240, v146
    v_add_f32 v240, v240, v147
    v_add_f32 v241, v241, v148
    v_add_f32 v241, v241, v149
    v_add_f32 v241, v241, v150
    v_add_f32 v241, v241, v151
    v_add_f32 v242, v242, v152
    v_add_f32 v242, v242, v153
    v_add_f32 v242, v242, v154
    v_add_f32 v242, v242, v155
    v_add_f32 v243, v243, v156
    v_add_f32 v243, v243, v157
    v_add_f32 v243, v243, v158
    v_add_f32 v243, v243, v159
    v_add_f32 v240, v240, v160
    v_add_f32 v240, v240, v161
    v_add_f32 v240, v240, v162
    v_add_f32 v240, v240, v163
    v_add_f32 v241, v241, v164
    v_add_f32 v241, v241, v165
    v_add_f32 v241, v241, v166
    v_add_f32 v241, v241, v167
    v_add_f32 v242, v242, v168
    v_add_f32 v242, v242, v169
    v_add_f32 v242, v242, v170
    v_add_f32 v242, v242, v171
    v_add_f32 v243, v243, v172
    v_add_f32 v243, v243, v173
    v_add_f32 v243, v243, v174
    v_add_f32 v243, v243, v175
    v_cvt_pk_bf16_f32 v208, v144, v145
    v_cvt_pk_bf16_f32 v209, v146, v147
    v_cvt_pk_bf16_f32 v212, v148, v149
    v_cvt_pk_bf16_f32 v213, v150, v151
    v_cvt_pk_bf16_f32 v216, v152, v153
    v_cvt_pk_bf16_f32 v217, v154, v155
    v_cvt_pk_bf16_f32 v220, v156, v157
    v_cvt_pk_bf16_f32 v221, v158, v159
    v_cvt_pk_bf16_f32 v210, v160, v161
    v_cvt_pk_bf16_f32 v211, v162, v163
    v_cvt_pk_bf16_f32 v214, v164, v165
    v_cvt_pk_bf16_f32 v215, v166, v167
    v_cvt_pk_bf16_f32 v218, v168, v169
    v_cvt_pk_bf16_f32 v219, v170, v171
    v_cvt_pk_bf16_f32 v222, v172, v173
    v_cvt_pk_bf16_f32 v223, v174, v175
    s_nop 1
    v_mfma_f32_16x16x32_bf16 v[16:19], v[208:211], a[124:127], v[16:19]
    v_mfma_f32_16x16x32_bf16 v[20:23], v[212:215], a[124:127], v[20:23]
    v_mfma_f32_16x16x32_bf16 v[24:27], v[216:219], a[124:127], v[24:27]
    v_mfma_f32_16x16x32_bf16 v[28:31], v[220:223], a[124:127], v[28:31]
    v_mfma_f32_16x16x32_bf16 v[32:35], v[208:211], a[128:131], v[32:35]
    v_mfma_f32_16x16x32_bf16 v[36:39], v[212:215], a[128:131], v[36:39]
    v_mfma_f32_16x16x32_bf16 v[40:43], v[216:219], a[128:131], v[40:43]
    v_mfma_f32_16x16x32_bf16 v[44:47], v[220:223], a[128:131], v[44:47]
    v_mfma_f32_16x16x32_bf16 v[48:51], v[208:211], a[132:135], v[48:51]
    v_mfma_f32_16x16x32_bf16 v[52:55], v[212:215], a[132:135], v[52:55]
    v_mfma_f32_16x16x32_bf16 v[56:59], v[216:219], a[132:135], v[56:59]
    v_mfma_f32_16x16x32_bf16 v[60:63], v[220:223], a[132:135], v[60:63]
    v_mfma_f32_16x16x32_bf16 v[64:67], v[208:211], a[136:139], v[64:67]
    v_mfma_f32_16x16x32_bf16 v[68:71], v[212:215], a[136:139], v[68:71]
    v_mfma_f32_16x16x32_bf16 v[72:75], v[216:219], a[136:139], v[72:75]
    v_mfma_f32_16x16x32_bf16 v[76:79], v[220:223], a[136:139], v[76:79]
    v_mfma_f32_16x16x32_bf16 v[80:83], v[208:211], a[140:143], v[80:83]
    v_mfma_f32_16x16x32_bf16 v[84:87], v[212:215], a[140:143], v[84:87]
    v_mfma_f32_16x16x32_bf16 v[88:91], v[216:219], a[140:143], v[88:91]
    v_mfma_f32_16x16x32_bf16 v[92:95], v[220:223], a[140:143], v[92:95]
    v_mfma_f32_16x16x32_bf16 v[96:99], v[208:211], a[144:147], v[96:99]
    v_mfma_f32_16x16x32_bf16 v[100:103], v[212:215], a[144:147], v[100:103]
    v_mfma_f32_16x16x32_bf16 v[104:107], v[216:219], a[144:147], v[104:107]
    v_mfma_f32_16x16x32_bf16 v[108:111], v[220:223], a[144:147], v[108:111]
    v_mfma_f32_16x16x32_bf16 v[112:115], v[208:211], a[148:151], v[112:115]
    v_mfma_f32_16x16x32_bf16 v[116:119], v[212:215], a[148:151], v[116:119]
    v_mfma_f32_16x16x32_bf16 v[120:123], v[216:219], a[148:151], v[120:123]
    v_mfma_f32_16x16x32_bf16 v[124:127], v[220:223], a[148:151], v[124:127]
    v_mfma_f32_16x16x32_bf16 v[128:131], v[208:211], a[152:155], v[128:131]
    v_mfma_f32_16x16x32_bf16 v[132:135], v[212:215], a[152:155], v[132:135]
    v_mfma_f32_16x16x32_bf16 v[136:139], v[216:219], a[152:155], v[136:139]
    v_mfma_f32_16x16x32_bf16 v[140:143], v[220:223], a[152:155], v[140:143]
    s_nop 7
    s_add_u32 s48, s48, 0x4000
    s_addc_u32 s49, s49, 0
    s_add_u32 s50, s50, 1
    s_cmp_lt_u32 s50, 8
    s_cbranch_scc1 L_slow1
    v_cvt_pk_bf16_f32 v84, v84, v85
    v_cvt_pk_bf16_f32 v85, v86, v87
    v_cvt_pk_bf16_f32 v100, v100, v101
    v_cvt_pk_bf16_f32 v101, v102, v103
    v_cvt_pk_bf16_f32 v116, v116, v117
    v_cvt_pk_bf16_f32 v117, v118, v119
    v_cvt_pk_bf16_f32 v132, v132, v133
    v_cvt_pk_bf16_f32 v133, v134, v135
    v_cvt_pk_bf16_f32 v20, v20, v21
    v_cvt_pk_bf16_f32 v21, v22, v23
    v_cvt_pk_bf16_f32 v22, v36, v37
    v_cvt_pk_bf16_f32 v23, v38, v39
    v_cvt_pk_bf16_f32 v52, v52, v53
    v_cvt_pk_bf16_f32 v53, v54, v55
    v_cvt_pk_bf16_f32 v54, v68, v69
    v_cvt_pk_bf16_f32 v55, v70, v71
    v_cvt_pk_bf16_f32 v80, v80, v81
    v_cvt_pk_bf16_f32 v81, v82, v83
    v_cvt_pk_bf16_f32 v96, v96, v97
    v_cvt_pk_bf16_f32 v97, v98, v99
    v_cvt_pk_bf16_f32 v112, v112, v113
    v_cvt_pk_bf16_f32 v113, v114, v115
    v_cvt_pk_bf16_f32 v128, v128, v129
    v_cvt_pk_bf16_f32 v129, v130, v131
    v_cvt_pk_bf16_f32 v92, v92, v93
    v_cvt_pk_bf16_f32 v93, v94, v95
    v_cvt_pk_bf16_f32 v108, v108, v109
    v_cvt_pk_bf16_f32 v109, v110, v111
    v_cvt_pk_bf16_f32 v124, v124, v125
    v_cvt_pk_bf16_f32 v125, v126, v127
    v_cvt_pk_bf16_f32 v140, v140, v141
    v_cvt_pk_bf16_f32 v141, v142, v143
    v_cvt_pk_bf16_f32 v28, v28, v29
    v_cvt_pk_bf16_f32 v29, v30, v31
    v_cvt_pk_bf16_f32 v30, v44, v45
    v_cvt_pk_bf16_f32 v31, v46, v47
    v_cvt_pk_bf16_f32 v60, v60, v61
    v_cvt_pk_bf16_f32 v61, v62, v63
    v_cvt_pk_bf16_f32 v62, v76, v77
    v_cvt_pk_bf16_f32 v63, v78, v79
    v_cvt_pk_bf16_f32 v88, v88, v89
    v_cvt_pk_bf16_f32 v89, v90, v91
    v_cvt_pk_bf16_f32 v104, v104, v105
    v_cvt_pk_bf16_f32 v105, v106, v107
    v_cvt_pk_bf16_f32 v120, v120, v121
    v_cvt_pk_bf16_f32 v121, v122, v123
    v_cvt_pk_bf16_f32 v136, v136, v137
    v_cvt_pk_bf16_f32 v137, v138, v139
    ds_write2st64_b64 v7, v[84:85], v[100:101] offset0:0 offset1:2
    ds_write2st64_b64 v7, v[116:117], v[132:133] offset0:4 offset1:6
    ds_write_b128 v6, v[20:23] offset:4096
    ds_write_b128 v6, v[52:55] offset:5120
    ds_write2st64_b64 v5, v[80:81], v[96:97] offset0:0 offset1:2
    ds_write2st64_b64 v5, v[112:113], v[128:129] offset0:4 offset1:6
    ds_write2st64_b64 v7, v[92:93], v[108:109] offset0:64 offset1:66
    ds_write2st64_b64 v7, v[124:125], v[140:141] offset0:68 offset1:70
    ds_write_b128 v6, v[28:31] offset:36864
    ds_write_b128 v6, v[60:63] offset:37888
    ds_write2st64_b64 v5, v[88:89], v[104:105] offset0:64 offset1:66
    ds_write2st64_b64 v5, v[120:121], v[136:137] offset0:68 offset1:70
    ds_write_b128 v252, v[240:243] offset:6144
    v_mov_b32 v14, 26624
    s_waitcnt lgkmcnt(0)
    s_barrier
    ds_read_b128 v[144:147], v9 offset:6144
    ds_read_b128 v[188:191], v6 offset:6144
    ds_read_b128 v[156:159], v10 offset:6144
    ds_read_b128 v[168:171], v4 offset:6144
    ds_read_b32 v15, v14
    s_waitcnt lgkmcnt(0)
    v_add_f32 v13, v144, v189
    v_add_f32 v14, v146, v191
    v_add_f32 v240, v168, v157
    v_add_f32 v242, v170, v159
    v_add_f32 v240, v240, v13
    v_add_f32 v242, v242, v14
    s_nop 0
    v_add_f32_dpp v240, v240, v240 row_ror:8 row_mask:0xf bank_mask:0xf
    v_add_f32_dpp v242, v242, v242 row_ror:8 row_mask:0xf bank_mask:0xf
    s_nop 0
    v_add_f32_dpp v240, v240, v240 row_ror:4 row_mask:0xf bank_mask:0xf
    v_add_f32_dpp v242, v242, v242 row_ror:4 row_mask:0xf bank_mask:0xf
    s_waitcnt lgkmcnt(0)
    s_barrier
    ds_read_b128 v[20:23], v4 offset:0
    ds_read_b128 v[84:87], v4 offset:4096
    ds_read_b128 v[36:39], v4 offset:1024
    ds_read_b128 v[52:55], v4 offset:2048
    ds_read_b128 v[100:103], v4 offset:5120
    ds_read_b128 v[68:71], v4 offset:3072
    s_waitcnt lgkmcnt(5)
    v_mfma_f32_16x16x32_bf16 v[16:19], a[70:73], v[20:23], v[16:19]
    v_mov_b32 v128, v240
    v_xor_b32 v3, 0x800, v11
    s_waitcnt lgkmcnt(4)
    v_mfma_f32_16x16x32_bf16 v[16:19], a[64:67], v[84:87], v[16:19]
    v_mov_b32_dpp v128, v248 quad_perm:[0,1,2,3] row_mask:0xf bank_mask:0x2
    v_add_u32 v129, s37, v128
    v_mfma_f32_16x16x32_bf16 v[32:35], a[68:71], v[84:87], v[32:35]
    s_xor_b32 s43, s36, s37
    s_waitcnt lgkmcnt(3)
    v_mfma_f32_16x16x32_bf16 v[32:35], a[70:73], v[36:39], v[32:35]
    s_waitcnt lgkmcnt(2)
    v_mfma_f32_16x16x32_bf16 v[48:51], a[70:73], v[52:55], v[48:51]
    s_nop 0
    s_nop 0
    s_waitcnt lgkmcnt(1)
    v_mfma_f32_16x16x32_bf16 v[48:51], a[64:67], v[100:103], v[48:51]
    v_cvt_pk_bf16_f32 v96, v16, v17
    v_cvt_pk_bf16_f32 v97, v18, v19
    v_mfma_f32_16x16x32_bf16 v[64:67], a[68:71], v[100:103], v[64:67]
    v_cvt_pk_bf16_f32 v98, v32, v33
    v_cvt_pk_bf16_f32 v99, v34, v35
    s_waitcnt lgkmcnt(0)
    v_mfma_f32_16x16x32_bf16 v[64:67], a[70:73], v[68:71], v[64:67]
    v_add3_u32 v129, v129, v96, v97
    v_xor_b32 v96, s37, v96
    global_store_dwordx4 v2, v[96:99], s[26:27] offset:0 sc1
    v_add3_u32 v129, v129, v98, v99
    v_cvt_pk_bf16_f32 v112, v48, v49
    v_cvt_pk_bf16_f32 v113, v50, v51
    s_nop 1
    v_cvt_pk_bf16_f32 v114, v64, v65
    v_cvt_pk_bf16_f32 v115, v66, v67
    v_add3_u32 v129, v129, v112, v113
    v_xor_b32 v112, s37, v112
    global_store_dwordx4 v2, v[112:115], s[26:27] offset:2048 sc1
    v_add3_u32 v129, v129, v114, v115
    global_store_dwordx2 v3, v[128:129], s[30:31] sc1
    s_waitcnt lgkmcnt(0)
    s_barrier
    ds_read_b128 v[20:23], v4 offset:32768
    ds_read_b128 v[36:39], v4 offset:33792
    ds_read_b128 v[52:55], v4 offset:34816
    ds_read_b128 v[68:71], v4 offset:35840
    ds_read_b128 v[84:87], v4 offset:36864
    ds_read_b128 v[100:103], v4 offset:37888
    global_load_dwordx4 v[16:19], v12, s[26:27] sc1
    global_load_dwordx4 v[32:35], v12, s[26:27] offset:2048 sc1
    global_load_dwordx2 v[48:49], v11, s[30:31] sc1
    s_branch L_comb
L_pad:
.fill (32768 - (L_pad - L_pc)) / 4 + 64, 4, 0xbf810000
.section .rodata,"a"
.p2align 6
.amdhsa_kernel standalone__kv_cache_quant_pre_rope_vs_post_rope__prompt_kernel
  .amdhsa_next_free_vgpr 464
  .amdhsa_next_free_sgpr 102
  .amdhsa_accum_offset 256
  .amdhsa_group_segment_fixed_size 0
  .amdhsa_kernarg_size 112
  .amdhsa_user_sgpr_count 2
  .amdhsa_user_sgpr_kernarg_segment_ptr 1
  .amdhsa_system_sgpr_workgroup_id_x 1
.end_amdhsa_kernel
```
